```python
import torch

def _softmax(x, axis=-1):
    return torch.softmax(x, dim=axis)
def _gelu(x):
    return torch.nn.functional.gelu(x, approximate="tanh")
def _silu(x):
    return torch.nn.functional.silu(x)
def _sigmoid(x):
    return torch.sigmoid(x)
def _layernorm(x, axis=-1, eps=1e-5):
    m = x.mean(dim=axis, keepdim=True)
    v = x.var(dim=axis, keepdim=True, unbiased=False)
    return (x - m) / torch.sqrt(v + eps)
def _scatter_add(tgt, idx, src, axis=0):
    return tgt.clone().index_add_(axis, idx, src)
def _segment_sum(src, seg, n):
    out = torch.zeros((n,) + src.shape[1:], dtype=src.dtype)
    return out.index_add_(0, seg, src)
def _pad(x, pw):
    flat = tuple(v for pair in reversed(pw) for v in pair)
    return torch.nn.functional.pad(x, flat)

kernel_name = 'gated_mix__ssm_conv_s4d__ssm_conv_h3__prompt'

def setup_inputs():

    _w = (lambda a: (lambda t: t.to(torch.bfloat16) if t.is_floating_point() else t)(torch.as_tensor(a)))
    def _A_setup():
        Bsz, L, D, N = 1, 2048, 1024, 128
        return {
            "u": _w((lambda *s: torch.randn(*s, dtype=torch.bfloat16) * 0.05)(Bsz, L, D)),
            "log_A_real": _w((lambda *s: torch.randn(*s, dtype=torch.bfloat16) * 3.2)(D, N) * 0.5),
            "A_imag": _w((lambda *s: torch.randn(*s, dtype=torch.bfloat16) * 0.05)(D, N) * 3.14),
            "C_real": _w((lambda *s: torch.randn(*s, dtype=torch.bfloat16) * 0.1)(D, N) / N ** 0.5),
            "C_imag": _w((lambda *s: torch.randn(*s, dtype=torch.bfloat16) * 0.1)(D, N) / N ** 0.5),
            "log_dt": _w((lambda *s: torch.randn(*s, dtype=torch.bfloat16) * 0.05)(D) * 0.5 - 4.0),
            "D_skip": _w((lambda *s: torch.randn(*s, dtype=torch.bfloat16) * 0.05)(D)),
        }
    _A_in = _A_setup()

    def _B_setup():
        B, S, D = 1, 2048, 1024
        ks = 4
        return {
            "q": _w((lambda *s: torch.randn(*s, dtype=torch.bfloat16) * 0.05)(B, S, D)),
            "k": _w((lambda *s: torch.randn(*s, dtype=torch.bfloat16) * 0.4)(B, S, D)),
            "v": _w((lambda *s: torch.randn(*s, dtype=torch.bfloat16) * 0.2)(B, S, D)),
            "shift_k": _w((lambda *s: torch.randn(*s, dtype=torch.bfloat16) * 0.4)(D, ks) * 0.5),
            "ssm_k": _w((lambda *s: torch.randn(*s, dtype=torch.bfloat16) * 0.4)(D, S) * (1.0 / S ** 0.5)),
            "ssm_D": _w((lambda *s: torch.randn(*s, dtype=torch.bfloat16) * 0.4)(D)),
        }
    _B_in = _B_setup()

    return {
        "A_u": _A_in["u"],
        "A_log_A_real": _A_in["log_A_real"],
        "A_A_imag": _A_in["A_imag"],
        "A_C_real": _A_in["C_real"],
        "A_C_imag": _A_in["C_imag"],
        "A_log_dt": _A_in["log_dt"],
        "A_D_skip": _A_in["D_skip"],
        "B_q": _B_in["q"],
        "B_k": _B_in["k"],
        "B_v": _B_in["v"],
        "B_shift_k": _B_in["shift_k"],
        "B_ssm_k": _B_in["ssm_k"],
        "B_ssm_D": _B_in["ssm_D"],
        "gate_w": _w((lambda *s: torch.randn(*s, dtype=torch.bfloat16) * 0.05)(1024) * 16.0),
    }

def reference(A_u, A_log_A_real, A_A_imag, A_C_real, A_C_imag, A_log_dt, A_D_skip, B_q, B_k, B_v, B_shift_k, B_ssm_k, B_ssm_D, gate_w):
    def _A_ref(u, log_A_real, A_imag, C_real, C_imag, log_dt, D_skip):
        L = u.shape[1]
        dt = torch.exp(log_dt)
        A = -torch.exp(log_A_real) + 1j * A_imag
        C = (C_real + 1j * C_imag) * dt[:, None]
        pos = (lambda x, dt: x.to(dt))(torch.arange(L), log_dt.dtype)
        P = torch.exp((A * dt[:, None])[:, :, None] * pos[None, None, :])
        K = 2.0 * torch.einsum("dn,dnl->dl", C, P).real
        L2 = 2 * L
        u_t = (lambda x, *d: x.permute(*d))(u, 0, 2, 1)
        Kf = (lambda x, *a, **k: torch.fft.rfft(x.float(), *a, **k))(K, L2)
        Uf = (lambda x, *a, **k: torch.fft.rfft(x.float(), *a, **k))(u_t, L2)
        y = (lambda x, *a, **k: torch.fft.irfft(x, *a, **k).to(torch.bfloat16))(Uf * Kf[None, :, :], L2)[:, :, :L]
        y = (lambda x, *d: x.permute(*d))(y, 0, 2, 1)
        return y + u * D_skip[None, None, :]

    def _B_ref(q, k, v, shift_k, ssm_k, ssm_D):
        B, S, D = q.shape
        ks = shift_k.shape[-1]
        k_pad = _pad(k, ((0, 0), (ks - 1, 0), (0, 0)))
        k_shift = torch.zeros_like(k)
        for t in range(ks):
            k_shift = k_shift + k_pad[:, t:t + S, :] * shift_k[:, ks - 1 - t][None, None, :]
        kv = k_shift * v
        L = 2 * S
        kv_pad = _pad(kv, ((0, 0), (0, S), (0, 0)))
        kf_pad = _pad(ssm_k, ((0, 0), (0, S)))
        kv_f = (lambda x, axes=(-2,-1): torch.fft.rfft2(x.float(), dim=axes))(kv_pad[:, None, :, :], axes=(1, 2))
        kf_f = (lambda x, axes=(-2,-1): torch.fft.rfft2(x.float(), dim=axes))(kf_pad[:, None, :], axes=(1, 2))
        kf_f = (lambda x, *d: x.permute(*d))(kf_f, 1, 2, 0)
        y_f = kv_f * kf_f[None, :, :, :]
        y = (lambda x, s, axes=(-2,-1): torch.fft.irfft2(x, s=s, dim=axes).to(torch.bfloat16))(y_f, (1, L), axes=(1, 2))[:, 0, :S, :]
        y = y + kv * ssm_D[None, None, :]
        return q * y

    x = A_u
    g = _sigmoid((x * gate_w).sum(-1, keepdims=True))
    a = _A_ref(x, A_log_A_real, A_A_imag, A_C_real, A_C_imag, A_log_dt, A_D_skip)
    b = _B_ref(x, B_k, B_v, B_shift_k, B_ssm_k, B_ssm_D)
    return g * a + (1 - g) * b
```

```asm
; @launch grid=(256,1,1) block=(512,1,1) lds=149824
.amdgcn_target "amdgcn-amd-amdhsa--gfx950"
.text
.globl gated_mix__ssm_conv_s4d__ssm_conv_h3__prompt_kernel
.p2align 8
.type gated_mix__ssm_conv_s4d__ssm_conv_h3__prompt_kernel,@function
gated_mix__ssm_conv_s4d__ssm_conv_h3__prompt_kernel:
  s_cmp_ge_u32 s2, 256
  s_cbranch_scc1 L_end
  s_load_dwordx16 s[16:31], s[0:1], 0
  s_load_dwordx16 s[32:47], s[0:1], 64
  s_load_dwordx2 s[48:49], s[0:1], 128
  s_getpc_b64 s[76:77]
L_pc:
  v_lshrrev_b32 v1, 6, v0
  v_and_b32 v2, 63, v0
  s_and_b32 s3, s2, 7
  v_readfirstlane_b32 s6, v1
  s_lshl_b32 s4, s3, 1
  s_bfe_u32 s3, s2, 0x10003
  s_or_b32 s4, s4, s3
  s_lshr_b32 s5, s2, 4
  s_lshl_b32 s60, s4, 6
  s_lshl_b32 s7, s5, 2
  s_add_u32 s60, s60, s7
  s_and_b32 s63, s6, 3
  s_lshr_b32 s64, s6, 2
  s_add_u32 s61, s63, s60
  s_lshl_b32 s7, s61, 8
  s_lshl_b32 s8, s64, 7
  s_add_u32 s7, s7, s8
  v_lshlrev_b32 v12, 1, v2
  v_add_u32 v12, s7, v12
  s_lshl_b32 s8, s61, 1
  v_mov_b32 v13, s8
  v_mov_b32 v16, 0
  v_mov_b32 v17, 0
  v_mov_b32 v18, 0
  v_mov_b32 v19, 0
  v_mov_b32 v9, 0
  v_mov_b32 v14, 0
  v_mov_b32 v170, 0
  v_mov_b32 v8, 0
  v_mov_b32 v11, 0
  v_and_b32 v20, 7, v2
  v_lshlrev_b32 v20, 4, v20
  v_add_u32 v20, 149696, v20
  ds_write_b128 v20, v[16:19]
  v_lshrrev_b32 v5, 3, v2
  v_and_b32 v6, 7, v2
  v_lshlrev_b32 v3, 11, v5
  v_lshl_add_u32 v3, v6, 4, v3
  s_lshl_b32 s7, s5, 2
  s_add_u32 s7, s7, s63
  s_lshl_b32 s7, s7, 16
  s_lshl_b32 s8, s4, 7
  s_add_u32 s7, s7, s8
  v_add_u32 v3, s7, v3
  s_waitcnt lgkmcnt(0)
  global_load_ushort v100, v12, s[18:19]
  global_load_ushort v104, v13, s[26:27]
  global_load_ushort v101, v12, s[20:21]
  global_load_ushort v102, v12, s[22:23]
  global_load_ushort v103, v12, s[24:25]
  s_barrier
  s_cmp_eq_u32 s64, 0
  s_cbranch_scc1 L_Aissue
  s_lshl_b32 s12, s4, 9
  v_and_b32 v11, 15, v2
  v_lshlrev_b32 v9, 3, v11
  v_add_u32 v9, s12, v9
  v_mov_b32 v11, 65536
  v_mov_b32 v224, 0
  v_mov_b32 v225, 0
  v_mov_b32 v226, 0
  v_mov_b32 v227, 0
  global_load_ushort v105, v13, s[40:41]
  global_load_dwordx4 v[128:131], v3, s[32:33] nt
  v_add_u32 v4, 16384, v3
  global_load_dwordx4 v[132:135], v4, s[32:33] nt
  v_add_u32 v4, 32768, v3
  global_load_dwordx4 v[136:139], v4, s[32:33] nt
  v_add_u32 v4, 49152, v3
  global_load_dwordx4 v[140:143], v4, s[32:33] nt
  s_add_u32 s7, s5, s63
  s_cmp_eq_u32 s7, 0
  s_cbranch_scc1 L_nohalo
  v_cmp_gt_u32 vcc, 24, v2
  s_nop 0
  s_and_saveexec_b64 s[14:15], vcc
  v_add_u32 v1, 0xffffe800, v3
  global_load_dwordx4 v[224:227], v1, s[32:33] nt
  s_mov_b64 exec, s[14:15]
L_nohalo:
  s_branch L_Bcalc
L_Aissue:
  v_mov_b32 v11, 65536
  global_load_ushort v105, v13, s[28:29]
  global_load_dwordx4 v[128:131], v3, s[16:17] nt
  v_add_u32 v4, 16384, v3
  global_load_dwordx4 v[132:135], v4, s[16:17] nt
  v_add_u32 v4, 32768, v3
  global_load_dwordx4 v[136:139], v4, s[16:17] nt
  v_add_u32 v4, 49152, v3
  global_load_dwordx4 v[140:143], v4, s[16:17] nt
  global_load_dword v107, v11, s[48:49] sc1
  s_lshr_b32 s7, s2, 3
  s_lshl_b32 s8, s6, 3
  s_add_u32 s7, s7, s8
  s_cmp_ge_u32 s7, 48
  s_cselect_b32 s8, 48, 0
  s_sub_u32 s7, s7, s8
  s_cmp_ge_u32 s7, 24
  s_cselect_b32 s8, 24, 0
  s_sub_u32 s7, s7, s8
  s_lshl_b32 s7, s7, 10
  v_lshlrev_b32 v1, 4, v2
  v_add_u32 v1, s7, v1
  v_cmp_gt_u32 vcc, L_codeend-L_pc-16, v1
  s_nop 0
  s_and_saveexec_b64 s[14:15], vcc
  s_cbranch_execz L_nopf1
  global_load_dwordx4 v[248:251], v1, s[76:77]
L_nopf1:
  s_mov_b64 exec, s[14:15]
L_nopf:
  v_mov_b32 v16, 0
  v_mov_b32 v17, 0
  v_mov_b32 v18, 0
  v_mov_b32 v19, 0
  s_mul_i32 s7, s63, 4128
  v_and_b32 v20, 1, v2
  v_lshlrev_b32 v20, 4, v20
  v_add_u32 v20, s7, v20
  ds_write_b128 v20, v[16:19] offset:0
  v_and_b32 v8, 15, v2
  v_lshlrev_b32 v8, 12, v8
  v_lshrrev_b32 v20, 4, v2
  v_lshl_add_u32 v8, v20, 4, v8
  s_lshl_b32 s50, s63, 6
  v_add_u32 v8, s50, v8
  s_lshl_b32 s50, s4, 18
  s_lshl_b32 s51, s5, 8
  s_add_u32 s50, s50, s51
  s_add_u32 s50, s50, 1048576
  s_add_u32 s54, s48, s50
  s_addc_u32 s55, s49, 0
  s_mul_i32 s7, s63, 4672
  s_add_u32 s7, s7, 131008
  v_mul_u32_u24 v7, 144, v5
  v_lshl_add_u32 v6, v6, 4, v7
  v_add_u32 v6, s7, v6
  v_bfe_u32 v7, v2, 2, 2
  v_lshrrev_b32 v20, 4, v2
  v_lshl_add_u32 v7, v7, 2, v20
  v_mul_u32_u24 v7, 144, v7
  v_and_b32 v20, 3, v2
  v_lshl_add_u32 v7, v20, 3, v7
  v_add_u32 v7, s7, v7
  s_waitcnt vmcnt(6)
  s_branch L_kgen
L_Bcalc:
  s_mul_i32 s13, s63, 9648
  s_add_u32 s13, s13, 92416
  v_mul_u32_u24 v7, 144, v5
  v_lshl_add_u32 v7, v6, 4, v7
  v_add_u32 v98, s13, v7
  v_and_b32 v5, 3, v2
  v_bfe_u32 v6, v2, 2, 2
  v_lshrrev_b32 v20, 4, v2
  v_lshl_add_u32 v168, v6, 2, v20
  v_mul_u32_u24 v168, 144, v168
  v_lshl_add_u32 v168, v5, 3, v168
  v_add_u32 v168, s13, v168
  v_add_u32 v169, v6, v20
  v_mul_u32_u24 v169, 144, v169
  v_lshl_add_u32 v169, v5, 3, v169
  v_add_u32 v169, s13, v169
  v_and_b32 v170, 15, v2
  v_lshlrev_b32 v170, 12, v170
  v_lshrrev_b32 v20, 4, v2
  v_lshl_add_u32 v170, v20, 4, v170
  s_lshl_b32 s50, s63, 6
  v_add_u32 v170, s50, v170
  s_lshl_b32 s50, s4, 18
  s_lshl_b32 s51, s5, 8
  s_add_u32 s50, s50, s51
  s_add_u32 s50, s50, 5242880
  s_add_u32 s54, s48, s50
  s_addc_u32 s55, s49, 0
  v_mov_b32 v16, 0
  v_mov_b32 v17, 0
  v_mov_b32 v18, 0
  v_mov_b32 v19, 0
  s_mul_i32 s8, s6, 4128
  v_and_b32 v20, 1, v2
  v_lshlrev_b32 v20, 4, v20
  v_add_u32 v20, s8, v20
  ds_write_b128 v20, v[16:19] offset:0
  s_lshl_b32 s8, s61, 12
  v_lshlrev_b32 v10, 4, v2
  v_add_u32 v14, s8, v10
  s_lshl_b32 s9, s2, 3
  s_lshl_b32 s8, s63, 1
  s_add_u32 s9, s9, s8
  s_lshl_b32 s8, s9, 11
  v_add_u32 v8, s8, v10
  s_waitcnt vmcnt(5)
L_kgen:
  s_waitcnt lgkmcnt(0)
  v_lshlrev_b32 v100, 16, v100
  v_lshlrev_b32 v104, 16, v104
  v_lshlrev_b32 v101, 16, v101
  v_lshlrev_b32 v102, 16, v102
  v_lshlrev_b32 v103, 16, v103
  v_mul_f32 v104, 0x3fb8aa3b, v104
  v_mul_f32 v100, 0x3fb8aa3b, v100
  v_exp_f32 v104, v104
  v_exp_f32 v100, v100
  s_mul_i32 s7, s6, 4352
  s_add_u32 s7, s7, 57600
  v_lshlrev_b32 v16, 2, v2
  v_add_u32 v16, s7, v16
  v_and_b32 v17, 15, v2
  v_mul_u32_u24 v17, 272, v17
  v_lshrrev_b32 v18, 4, v2
  v_lshl_add_u32 v17, v18, 4, v17
  v_add_u32 v17, s7, v17
  v_cvt_pk_bf16_f32 v106, v104, v100
  v_lshlrev_b32 v104, 16, v106
  v_and_b32 v100, 0xffff0000, v106
  v_mul_f32 v100, v100, v104
  v_mul_f32 v101, v101, v104
  v_mul_f32 v100, 0xbfb8aa3b, v100
  v_mul_f32 v101, 0.15915494, v101
  v_add_f32 v104, v104, v104
  v_mul_f32 v20, v102, v104
  v_mul_f32 v21, v103, v104
  v_mul_f32 v40, 0x41000000, v100
  v_mul_f32 v41, 0x41000000, v101
  v_mul_f32 v42, 0x43000000, v100
  v_mul_f32 v43, 0x43000000, v101
  v_exp_f32 v44, v100
  v_fract_f32 v45, v101
  v_exp_f32 v40, v40
  v_fract_f32 v41, v41
  v_exp_f32 v42, v42
  v_fract_f32 v43, v43
  v_cos_f32 v24, v41
  v_sin_f32 v25, v41
  v_cos_f32 v22, v45
  v_sin_f32 v23, v45
  v_cos_f32 v26, v43
  v_sin_f32 v27, v43
  v_mul_f32 v24, v24, v40
  v_mul_f32 v25, v25, v40
  v_mul_f32 v22, v22, v44
  v_mul_f32 v23, v23, v44
  v_mul_f32 v26, v26, v42
  v_mul_f32 v27, v27, v42
  v_mov_b32 v32, 1.0
  v_mov_b32 v33, 0
  v_mov_b32 v34, v22
  v_mov_b32 v35, v23
  v_cvt_pk_bf16_f32 v19, v20, -v21
  ds_write_b32 v16, v19 offset:0
  v_pk_mul_f32 v[28:29], v[20:21], v[24:25] op_sel:[1,1] op_sel_hi:[1,0]
  v_pk_fma_f32 v[20:21], v[20:21], v[24:25], v[28:29] op_sel:[0,0,0] op_sel_hi:[0,1,1] neg_lo:[0,0,1]
  v_pk_mul_f32 v[30:31], v[34:35], v[22:23] op_sel:[1,1] op_sel_hi:[1,0]
  v_pk_fma_f32 v[36:37], v[34:35], v[22:23], v[30:31] op_sel:[0,0,0] op_sel_hi:[0,1,1] neg_lo:[0,0,1]
  v_cvt_pk_bf16_f32 v19, v20, -v21
  ds_write_b32 v16, v19 offset:272
  v_pk_mul_f32 v[28:29], v[20:21], v[24:25] op_sel:[1,1] op_sel_hi:[1,0]
  v_pk_fma_f32 v[20:21], v[20:21], v[24:25], v[28:29] op_sel:[0,0,0] op_sel_hi:[0,1,1] neg_lo:[0,0,1]
  v_pk_mul_f32 v[30:31], v[36:37], v[22:23] op_sel:[1,1] op_sel_hi:[1,0]
  v_pk_fma_f32 v[38:39], v[36:37], v[22:23], v[30:31] op_sel:[0,0,0] op_sel_hi:[0,1,1] neg_lo:[0,0,1]
  v_cvt_pk_bf16_f32 v19, v20, -v21
  ds_write_b32 v16, v19 offset:544
  v_pk_mul_f32 v[28:29], v[20:21], v[24:25] op_sel:[1,1] op_sel_hi:[1,0]
  v_pk_fma_f32 v[20:21], v[20:21], v[24:25], v[28:29] op_sel:[0,0,0] op_sel_hi:[0,1,1] neg_lo:[0,0,1]
  v_pk_mul_f32 v[30:31], v[38:39], v[22:23] op_sel:[1,1] op_sel_hi:[1,0]
  v_pk_fma_f32 v[40:41], v[38:39], v[22:23], v[30:31] op_sel:[0,0,0] op_sel_hi:[0,1,1] neg_lo:[0,0,1]
  v_cvt_pk_bf16_f32 v19, v20, -v21
  ds_write_b32 v16, v19 offset:816
  v_pk_mul_f32 v[28:29], v[20:21], v[24:25] op_sel:[1,1] op_sel_hi:[1,0]
  v_pk_fma_f32 v[20:21], v[20:21], v[24:25], v[28:29] op_sel:[0,0,0] op_sel_hi:[0,1,1] neg_lo:[0,0,1]
  v_pk_mul_f32 v[30:31], v[40:41], v[22:23] op_sel:[1,1] op_sel_hi:[1,0]
  v_pk_fma_f32 v[42:43], v[40:41], v[22:23], v[30:31] op_sel:[0,0,0] op_sel_hi:[0,1,1] neg_lo:[0,0,1]
  v_cvt_pk_bf16_f32 v19, v20, -v21
  ds_write_b32 v16, v19 offset:1088
  v_pk_mul_f32 v[28:29], v[20:21], v[24:25] op_sel:[1,1] op_sel_hi:[1,0]
  v_pk_fma_f32 v[20:21], v[20:21], v[24:25], v[28:29] op_sel:[0,0,0] op_sel_hi:[0,1,1] neg_lo:[0,0,1]
  v_pk_mul_f32 v[30:31], v[42:43], v[22:23] op_sel:[1,1] op_sel_hi:[1,0]
  v_pk_fma_f32 v[44:45], v[42:43], v[22:23], v[30:31] op_sel:[0,0,0] op_sel_hi:[0,1,1] neg_lo:[0,0,1]
  v_cvt_pk_bf16_f32 v19, v20, -v21
  ds_write_b32 v16, v19 offset:1360
  v_pk_mul_f32 v[28:29], v[20:21], v[24:25] op_sel:[1,1] op_sel_hi:[1,0]
  v_pk_fma_f32 v[20:21], v[20:21], v[24:25], v[28:29] op_sel:[0,0,0] op_sel_hi:[0,1,1] neg_lo:[0,0,1]
  v_pk_mul_f32 v[30:31], v[44:45], v[22:23] op_sel:[1,1] op_sel_hi:[1,0]
  v_pk_fma_f32 v[46:47], v[44:45], v[22:23], v[30:31] op_sel:[0,0,0] op_sel_hi:[0,1,1] neg_lo:[0,0,1]
  v_cvt_pk_bf16_f32 v19, v20, -v21
  ds_write_b32 v16, v19 offset:1632
  v_pk_mul_f32 v[28:29], v[20:21], v[24:25] op_sel:[1,1] op_sel_hi:[1,0]
  v_pk_fma_f32 v[20:21], v[20:21], v[24:25], v[28:29] op_sel:[0,0,0] op_sel_hi:[0,1,1] neg_lo:[0,0,1]
  v_pk_mul_f32 v[30:31], v[26:27], v[26:27] op_sel:[1,1] op_sel_hi:[1,0]
  v_pk_fma_f32 v[50:51], v[26:27], v[26:27], v[30:31] op_sel:[0,0,0] op_sel_hi:[0,1,1] neg_lo:[0,0,1]
  v_cvt_pk_bf16_f32 v19, v20, -v21
  ds_write_b32 v16, v19 offset:1904
  v_pk_mul_f32 v[28:29], v[20:21], v[24:25] op_sel:[1,1] op_sel_hi:[1,0]
  v_pk_fma_f32 v[20:21], v[20:21], v[24:25], v[28:29] op_sel:[0,0,0] op_sel_hi:[0,1,1] neg_lo:[0,0,1]
  v_cvt_pk_bf16_f32 v19, v20, -v21
  ds_write_b32 v16, v19 offset:2176
  v_pk_mul_f32 v[28:29], v[20:21], v[24:25] op_sel:[1,1] op_sel_hi:[1,0]
  v_pk_fma_f32 v[20:21], v[20:21], v[24:25], v[28:29] op_sel:[0,0,0] op_sel_hi:[0,1,1] neg_lo:[0,0,1]
  v_cvt_pk_bf16_f32 v19, v20, -v21
  ds_write_b32 v16, v19 offset:2448
  v_pk_mul_f32 v[28:29], v[20:21], v[24:25] op_sel:[1,1] op_sel_hi:[1,0]
  v_pk_fma_f32 v[20:21], v[20:21], v[24:25], v[28:29] op_sel:[0,0,0] op_sel_hi:[0,1,1] neg_lo:[0,0,1]
  v_cvt_pk_bf16_f32 v19, v20, -v21
  ds_write_b32 v16, v19 offset:2720
  v_pk_mul_f32 v[28:29], v[20:21], v[24:25] op_sel:[1,1] op_sel_hi:[1,0]
  v_pk_fma_f32 v[20:21], v[20:21], v[24:25], v[28:29] op_sel:[0,0,0] op_sel_hi:[0,1,1] neg_lo:[0,0,1]
  v_cvt_pk_bf16_f32 v19, v20, -v21
  ds_write_b32 v16, v19 offset:2992
  v_pk_mul_f32 v[28:29], v[20:21], v[24:25] op_sel:[1,1] op_sel_hi:[1,0]
  v_pk_fma_f32 v[20:21], v[20:21], v[24:25], v[28:29] op_sel:[0,0,0] op_sel_hi:[0,1,1] neg_lo:[0,0,1]
  v_cvt_pk_bf16_f32 v19, v20, -v21
  ds_write_b32 v16, v19 offset:3264
  s_waitcnt lgkmcnt(0)
  s_cmp_lg_u32 s64, 0
  s_cbranch_scc1 L_ah2
  s_waitcnt vmcnt(1)
  ds_write_b128 v6, v[128:131] offset:0
  ds_write_b128 v6, v[132:135] offset:1152
  ds_write_b128 v6, v[136:139] offset:2304
  ds_write_b128 v6, v[140:143] offset:3456
  ds_read_b64_tr_b16 v[144:145], v7 offset:0
  ds_read_b64_tr_b16 v[146:147], v7 offset:2304
  ds_read_b64_tr_b16 v[148:149], v7 offset:32
  ds_read_b64_tr_b16 v[150:151], v7 offset:2336
  ds_read_b64_tr_b16 v[152:153], v7 offset:64
  ds_read_b64_tr_b16 v[154:155], v7 offset:2368
  ds_read_b64_tr_b16 v[156:157], v7 offset:96
  ds_read_b64_tr_b16 v[158:159], v7 offset:2400
  s_waitcnt lgkmcnt(6)
  global_store_dwordx4 v8, v[144:147], s[54:55] sc1
  v_add_u32 v4, 65536, v8
  s_waitcnt lgkmcnt(4)
  global_store_dwordx4 v4, v[148:151], s[54:55] sc1
  s_nop 1
  v_add_u32 v4, 131072, v8
  s_waitcnt lgkmcnt(2)
  global_store_dwordx4 v4, v[152:155], s[54:55] sc1
  s_nop 1
  v_add_u32 v4, 196608, v8
  s_waitcnt lgkmcnt(0)
  global_store_dwordx4 v4, v[156:159], s[54:55] sc1
  s_waitcnt lgkmcnt(0)
L_ah2:
  v_pk_mul_f32 v[28:29], v[20:21], v[24:25] op_sel:[1,1] op_sel_hi:[1,0]
  v_pk_fma_f32 v[20:21], v[20:21], v[24:25], v[28:29] op_sel:[0,0,0] op_sel_hi:[0,1,1] neg_lo:[0,0,1]
  v_cvt_pk_bf16_f32 v19, v20, -v21
  ds_write_b32 v16, v19 offset:3536
  v_pk_mul_f32 v[28:29], v[20:21], v[24:25] op_sel:[1,1] op_sel_hi:[1,0]
  v_pk_fma_f32 v[20:21], v[20:21], v[24:25], v[28:29] op_sel:[0,0,0] op_sel_hi:[0,1,1] neg_lo:[0,0,1]
  v_cvt_pk_bf16_f32 v19, v20, -v21
  ds_write_b32 v16, v19 offset:3808
  v_pk_mul_f32 v[28:29], v[20:21], v[24:25] op_sel:[1,1] op_sel_hi:[1,0]
  v_pk_fma_f32 v[20:21], v[20:21], v[24:25], v[28:29] op_sel:[0,0,0] op_sel_hi:[0,1,1] neg_lo:[0,0,1]
  v_cvt_pk_bf16_f32 v19, v20, -v21
  ds_write_b32 v16, v19 offset:4080
  ds_read_b128 v[52:55], v17 offset:0
  ds_read_b128 v[56:59], v17 offset:64
  ds_read_b128 v[60:63], v17 offset:128
  ds_read_b128 v[64:67], v17 offset:192
  v_cvt_pk_bf16_f32 v18, v32, v33
  ds_write_b32 v16, v18 offset:0
  v_cvt_pk_bf16_f32 v19, v34, v35
  ds_write_b32 v16, v19 offset:272
  v_cvt_pk_bf16_f32 v18, v36, v37
  ds_write_b32 v16, v18 offset:544
  v_cvt_pk_bf16_f32 v19, v38, v39
  ds_write_b32 v16, v19 offset:816
  v_cvt_pk_bf16_f32 v18, v40, v41
  ds_write_b32 v16, v18 offset:1088
  v_cvt_pk_bf16_f32 v19, v42, v43
  ds_write_b32 v16, v19 offset:1360
  v_cvt_pk_bf16_f32 v18, v44, v45
  ds_write_b32 v16, v18 offset:1632
  v_cvt_pk_bf16_f32 v19, v46, v47
  ds_write_b32 v16, v19 offset:1904
  v_cvt_pk_bf16_f32 v19, v26, v27
  ds_write_b32 v16, v19 offset:2176
  v_pk_mul_f32 v[28:29], v[26:27], v[34:35] op_sel:[1,1] op_sel_hi:[1,0]
  v_pk_fma_f32 v[48:49], v[26:27], v[34:35], v[28:29] op_sel:[0,0,0] op_sel_hi:[0,1,1] neg_lo:[0,0,1]
  v_cvt_pk_bf16_f32 v19, v48, v49
  ds_write_b32 v16, v19 offset:2448
  v_pk_mul_f32 v[30:31], v[26:27], v[36:37] op_sel:[1,1] op_sel_hi:[1,0]
  v_pk_fma_f32 v[96:97], v[26:27], v[36:37], v[30:31] op_sel:[0,0,0] op_sel_hi:[0,1,1] neg_lo:[0,0,1]
  v_cvt_pk_bf16_f32 v18, v96, v97
  ds_write_b32 v16, v18 offset:2720
  v_pk_mul_f32 v[28:29], v[26:27], v[38:39] op_sel:[1,1] op_sel_hi:[1,0]
  v_pk_fma_f32 v[48:49], v[26:27], v[38:39], v[28:29] op_sel:[0,0,0] op_sel_hi:[0,1,1] neg_lo:[0,0,1]
  v_cvt_pk_bf16_f32 v19, v48, v49
  ds_write_b32 v16, v19 offset:2992
  v_pk_mul_f32 v[30:31], v[26:27], v[40:41] op_sel:[1,1] op_sel_hi:[1,0]
  v_pk_fma_f32 v[96:97], v[26:27], v[40:41], v[30:31] op_sel:[0,0,0] op_sel_hi:[0,1,1] neg_lo:[0,0,1]
  v_cvt_pk_bf16_f32 v18, v96, v97
  ds_write_b32 v16, v18 offset:3264
  v_pk_mul_f32 v[28:29], v[26:27], v[42:43] op_sel:[1,1] op_sel_hi:[1,0]
  v_pk_fma_f32 v[48:49], v[26:27], v[42:43], v[28:29] op_sel:[0,0,0] op_sel_hi:[0,1,1] neg_lo:[0,0,1]
  v_cvt_pk_bf16_f32 v19, v48, v49
  ds_write_b32 v16, v19 offset:3536
  v_pk_mul_f32 v[30:31], v[26:27], v[44:45] op_sel:[1,1] op_sel_hi:[1,0]
  v_pk_fma_f32 v[96:97], v[26:27], v[44:45], v[30:31] op_sel:[0,0,0] op_sel_hi:[0,1,1] neg_lo:[0,0,1]
  v_cvt_pk_bf16_f32 v18, v96, v97
  ds_write_b32 v16, v18 offset:3808
  v_pk_mul_f32 v[28:29], v[26:27], v[46:47] op_sel:[1,1] op_sel_hi:[1,0]
  v_pk_fma_f32 v[48:49], v[26:27], v[46:47], v[28:29] op_sel:[0,0,0] op_sel_hi:[0,1,1] neg_lo:[0,0,1]
  v_cvt_pk_bf16_f32 v19, v48, v49
  ds_write_b32 v16, v19 offset:4080
  ds_read_b128 v[68:71], v17 offset:0
  ds_read_b128 v[72:75], v17 offset:64
  ds_read_b128 v[76:79], v17 offset:128
  ds_read_b128 v[80:83], v17 offset:192
  s_cmp_eq_u32 s64, 0
  s_cbranch_scc1 L_bh3
  global_load_dwordx4 v[144:147], v3, s[34:35] nt
  v_add_u32 v4, 16384, v3
  global_load_dwordx4 v[148:151], v4, s[34:35] nt
  v_add_u32 v4, 32768, v3
  global_load_dwordx4 v[152:155], v4, s[34:35] nt
  v_add_u32 v4, 49152, v3
  global_load_dwordx4 v[156:159], v4, s[34:35] nt
  global_load_dwordx2 v[228:229], v9, s[36:37] offset:0
  global_load_dwordx2 v[230:231], v9, s[36:37] offset:128
  global_load_dwordx2 v[232:233], v9, s[36:37] offset:256
  global_load_dwordx2 v[234:235], v9, s[36:37] offset:384
  global_load_dword v107, v11, s[48:49] sc1
L_bh3:
  v_cvt_pk_bf16_f32 v19, v50, v51
  ds_write_b32 v16, v19 offset:0
  v_pk_mul_f32 v[28:29], v[50:51], v[36:37] op_sel:[1,1] op_sel_hi:[1,0]
  v_pk_fma_f32 v[48:49], v[50:51], v[36:37], v[28:29] op_sel:[0,0,0] op_sel_hi:[0,1,1] neg_lo:[0,0,1]
  v_cvt_pk_bf16_f32 v19, v48, v49
  ds_write_b32 v16, v19 offset:272
  v_pk_mul_f32 v[30:31], v[50:51], v[40:41] op_sel:[1,1] op_sel_hi:[1,0]
  v_pk_fma_f32 v[96:97], v[50:51], v[40:41], v[30:31] op_sel:[0,0,0] op_sel_hi:[0,1,1] neg_lo:[0,0,1]
  v_cvt_pk_bf16_f32 v18, v96, v97
  ds_write_b32 v16, v18 offset:544
  v_pk_mul_f32 v[28:29], v[50:51], v[44:45] op_sel:[1,1] op_sel_hi:[1,0]
  v_pk_fma_f32 v[48:49], v[50:51], v[44:45], v[28:29] op_sel:[0,0,0] op_sel_hi:[0,1,1] neg_lo:[0,0,1]
  v_cvt_pk_bf16_f32 v19, v48, v49
  ds_write_b32 v16, v19 offset:816
  v_pk_mul_f32 v[28:29], v[50:51], v[26:27] op_sel:[1,1] op_sel_hi:[1,0]
  v_pk_fma_f32 v[50:51], v[50:51], v[26:27], v[28:29] op_sel:[0,0,0] op_sel_hi:[0,1,1] neg_lo:[0,0,1]
  s_waitcnt lgkmcnt(7)
  v_mfma_f32_16x16x32_bf16 v[84:87], v[68:71], v[52:55], 0
  s_waitcnt lgkmcnt(6)
  v_mfma_f32_16x16x32_bf16 v[84:87], v[72:75], v[56:59], v[84:87]
  s_waitcnt lgkmcnt(5)
  v_mfma_f32_16x16x32_bf16 v[84:87], v[76:79], v[60:63], v[84:87]
  s_waitcnt lgkmcnt(4)
  v_mfma_f32_16x16x32_bf16 v[84:87], v[80:83], v[64:67], v[84:87]
  v_cvt_pk_bf16_f32 v19, v50, v51
  ds_write_b32 v16, v19 offset:1088
  v_pk_mul_f32 v[28:29], v[50:51], v[36:37] op_sel:[1,1] op_sel_hi:[1,0]
  v_pk_fma_f32 v[48:49], v[50:51], v[36:37], v[28:29] op_sel:[0,0,0] op_sel_hi:[0,1,1] neg_lo:[0,0,1]
  v_cvt_pk_bf16_f32 v19, v48, v49
  ds_write_b32 v16, v19 offset:1360
  v_pk_mul_f32 v[30:31], v[50:51], v[40:41] op_sel:[1,1] op_sel_hi:[1,0]
  v_pk_fma_f32 v[96:97], v[50:51], v[40:41], v[30:31] op_sel:[0,0,0] op_sel_hi:[0,1,1] neg_lo:[0,0,1]
  v_cvt_pk_bf16_f32 v18, v96, v97
  ds_write_b32 v16, v18 offset:1632
  v_pk_mul_f32 v[28:29], v[50:51], v[44:45] op_sel:[1,1] op_sel_hi:[1,0]
  v_pk_fma_f32 v[48:49], v[50:51], v[44:45], v[28:29] op_sel:[0,0,0] op_sel_hi:[0,1,1] neg_lo:[0,0,1]
  v_cvt_pk_bf16_f32 v19, v48, v49
  ds_write_b32 v16, v19 offset:1904
  v_pk_mul_f32 v[28:29], v[50:51], v[26:27] op_sel:[1,1] op_sel_hi:[1,0]
  v_pk_fma_f32 v[50:51], v[50:51], v[26:27], v[28:29] op_sel:[0,0,0] op_sel_hi:[0,1,1] neg_lo:[0,0,1]
  v_cvt_pk_bf16_f32 v19, v50, v51
  ds_write_b32 v16, v19 offset:2176
  v_pk_mul_f32 v[30:31], v[50:51], v[40:41] op_sel:[1,1] op_sel_hi:[1,0]
  v_pk_fma_f32 v[48:49], v[50:51], v[40:41], v[30:31] op_sel:[0,0,0] op_sel_hi:[0,1,1] neg_lo:[0,0,1]
  v_pk_mul_f32 v[28:29], v[50:51], v[26:27] op_sel:[1,1] op_sel_hi:[1,0]
  v_pk_fma_f32 v[96:97], v[50:51], v[26:27], v[28:29] op_sel:[0,0,0] op_sel_hi:[0,1,1] neg_lo:[0,0,1]
  v_cvt_pk_bf16_f32 v18, v48, v49
  ds_write_b32 v16, v18 offset:2448
  v_mov_b32 v50, v96
  v_mov_b32 v51, v97
  v_cvt_pk_bf16_f32 v19, v50, v51
  ds_write_b32 v16, v19 offset:2720
  v_pk_mul_f32 v[30:31], v[50:51], v[40:41] op_sel:[1,1] op_sel_hi:[1,0]
  v_pk_fma_f32 v[48:49], v[50:51], v[40:41], v[30:31] op_sel:[0,0,0] op_sel_hi:[0,1,1] neg_lo:[0,0,1]
  v_pk_mul_f32 v[28:29], v[50:51], v[26:27] op_sel:[1,1] op_sel_hi:[1,0]
  v_pk_fma_f32 v[96:97], v[50:51], v[26:27], v[28:29] op_sel:[0,0,0] op_sel_hi:[0,1,1] neg_lo:[0,0,1]
  v_cvt_pk_bf16_f32 v18, v48, v49
  ds_write_b32 v16, v18 offset:2992
  v_mov_b32 v50, v96
  v_mov_b32 v51, v97
  v_cvt_pk_bf16_f32 v19, v50, v51
  ds_write_b32 v16, v19 offset:3264
  v_pk_mul_f32 v[30:31], v[50:51], v[40:41] op_sel:[1,1] op_sel_hi:[1,0]
  v_pk_fma_f32 v[48:49], v[50:51], v[40:41], v[30:31] op_sel:[0,0,0] op_sel_hi:[0,1,1] neg_lo:[0,0,1]
  v_pk_mul_f32 v[28:29], v[50:51], v[26:27] op_sel:[1,1] op_sel_hi:[1,0]
  v_pk_fma_f32 v[96:97], v[50:51], v[26:27], v[28:29] op_sel:[0,0,0] op_sel_hi:[0,1,1] neg_lo:[0,0,1]
  v_cvt_pk_bf16_f32 v18, v48, v49
  ds_write_b32 v16, v18 offset:3536
  v_mov_b32 v50, v96
  v_mov_b32 v51, v97
  v_cvt_pk_bf16_f32 v19, v50, v51
  ds_write_b32 v16, v19 offset:3808
  v_pk_mul_f32 v[30:31], v[50:51], v[40:41] op_sel:[1,1] op_sel_hi:[1,0]
  v_pk_fma_f32 v[48:49], v[50:51], v[40:41], v[30:31] op_sel:[0,0,0] op_sel_hi:[0,1,1] neg_lo:[0,0,1]
  v_pk_mul_f32 v[28:29], v[50:51], v[26:27] op_sel:[1,1] op_sel_hi:[1,0]
  v_pk_fma_f32 v[96:97], v[50:51], v[26:27], v[28:29] op_sel:[0,0,0] op_sel_hi:[0,1,1] neg_lo:[0,0,1]
  v_cvt_pk_bf16_f32 v18, v48, v49
  ds_write_b32 v16, v18 offset:4080
  v_mov_b32 v50, v96
  v_mov_b32 v51, v97
  s_cmp_lg_u32 s64, 0
  s_cbranch_scc1 L_xf4
  s_waitcnt vmcnt(0)
  v_readfirstlane_b32 s75, v107
  s_nop 0
  s_mul_i32 s74, s75, 0x9e3779b1
  s_add_u32 s74, s74, 0x7f4a7c15
  s_lshl_b32 s7, s4, 1
  s_lshl_b32 s7, s7, 4
  s_add_u32 s7, s7, s5
  s_lshl_b32 s7, s7, 2
  s_add_u32 s7, s7, s63
  s_lshl_b32 s7, s7, 4
  v_mov_b32 v4, s7
  v_mov_b32 v5, s74
  s_mov_b64 exec, 1
  global_store_dword v4, v5, s[48:49] sc1
  s_mov_b64 exec, -1
L_xf4:
  ds_read_b128 v[108:111], v17 offset:0
  ds_read_b128 v[112:115], v17 offset:64
  ds_read_b128 v[116:119], v17 offset:128
  ds_read_b128 v[120:123], v17 offset:192
  v_cvt_pk_bf16_f32 v18, v50, v51
  ds_write_b32 v16, v18 offset:0
  v_pk_mul_f32 v[28:29], v[50:51], v[26:27] op_sel:[1,1] op_sel_hi:[1,0]
  v_pk_fma_f32 v[50:51], v[50:51], v[26:27], v[28:29] op_sel:[0,0,0] op_sel_hi:[0,1,1] neg_lo:[0,0,1]
  v_cvt_pk_bf16_f32 v19, v50, v51
  ds_write_b32 v16, v19 offset:272
  v_pk_mul_f32 v[28:29], v[50:51], v[26:27] op_sel:[1,1] op_sel_hi:[1,0]
  v_pk_fma_f32 v[50:51], v[50:51], v[26:27], v[28:29] op_sel:[0,0,0] op_sel_hi:[0,1,1] neg_lo:[0,0,1]
  v_cvt_pk_bf16_f32 v18, v50, v51
  ds_write_b32 v16, v18 offset:544
  v_pk_mul_f32 v[28:29], v[50:51], v[26:27] op_sel:[1,1] op_sel_hi:[1,0]
  v_pk_fma_f32 v[50:51], v[50:51], v[26:27], v[28:29] op_sel:[0,0,0] op_sel_hi:[0,1,1] neg_lo:[0,0,1]
  s_waitcnt lgkmcnt(6)
  v_mfma_f32_16x16x32_bf16 v[88:91], v[108:111], v[52:55], 0
  s_waitcnt lgkmcnt(5)
  v_mfma_f32_16x16x32_bf16 v[88:91], v[112:115], v[56:59], v[88:91]
  s_waitcnt lgkmcnt(4)
  v_mfma_f32_16x16x32_bf16 v[88:91], v[116:119], v[60:63], v[88:91]
  s_waitcnt lgkmcnt(3)
  v_mfma_f32_16x16x32_bf16 v[88:91], v[120:123], v[64:67], v[88:91]
  v_cvt_pk_bf16_f32 v19, v50, v51
  ds_write_b32 v16, v19 offset:816
  v_pk_mul_f32 v[28:29], v[50:51], v[26:27] op_sel:[1,1] op_sel_hi:[1,0]
  v_pk_fma_f32 v[50:51], v[50:51], v[26:27], v[28:29] op_sel:[0,0,0] op_sel_hi:[0,1,1] neg_lo:[0,0,1]
  v_cvt_pk_bf16_f32 v18, v50, v51
  ds_write_b32 v16, v18 offset:1088
  v_pk_mul_f32 v[28:29], v[50:51], v[26:27] op_sel:[1,1] op_sel_hi:[1,0]
  v_pk_fma_f32 v[50:51], v[50:51], v[26:27], v[28:29] op_sel:[0,0,0] op_sel_hi:[0,1,1] neg_lo:[0,0,1]
  v_cvt_pk_bf16_f32 v19, v50, v51
  ds_write_b32 v16, v19 offset:1360
  v_pk_mul_f32 v[28:29], v[50:51], v[26:27] op_sel:[1,1] op_sel_hi:[1,0]
  v_pk_fma_f32 v[50:51], v[50:51], v[26:27], v[28:29] op_sel:[0,0,0] op_sel_hi:[0,1,1] neg_lo:[0,0,1]
  v_cvt_pk_bf16_f32 v18, v50, v51
  ds_write_b32 v16, v18 offset:1632
  v_pk_mul_f32 v[28:29], v[50:51], v[26:27] op_sel:[1,1] op_sel_hi:[1,0]
  v_pk_fma_f32 v[50:51], v[50:51], v[26:27], v[28:29] op_sel:[0,0,0] op_sel_hi:[0,1,1] neg_lo:[0,0,1]
  v_cvt_pk_bf16_f32 v19, v50, v51
  ds_write_b32 v16, v19 offset:1904
  v_pk_mul_f32 v[28:29], v[50:51], v[26:27] op_sel:[1,1] op_sel_hi:[1,0]
  v_pk_fma_f32 v[50:51], v[50:51], v[26:27], v[28:29] op_sel:[0,0,0] op_sel_hi:[0,1,1] neg_lo:[0,0,1]
  v_cvt_pk_bf16_f32 v18, v50, v51
  ds_write_b32 v16, v18 offset:2176
  ds_read_b128 v[68:71], v17 offset:0
  ds_read_b128 v[72:75], v17 offset:64
  ds_read_b128 v[76:79], v17 offset:128
  ds_read_b128 v[80:83], v17 offset:192
  v_and_b32 v30, 15, v2
  v_lshrrev_b32 v31, 4, v2
  s_mul_i32 s7, s63, 3072
  s_add_u32 s7, s7, 33024
  s_mul_i32 s8, s64, 12288
  s_add_u32 s7, s7, s8
  v_lshrrev_b32 v32, 1, v31
  v_lshlrev_b32 v32, 7, v32
  v_and_b32 v33, 1, v31
  v_lshl_add_u32 v32, v33, 2, v32
  v_lshl_add_u32 v32, v30, 3, v32
  v_lshlrev_b32 v32, 2, v32
  v_add_u32 v32, s7, v32
  v_cmp_gt_u32 vcc, 2, v31
  v_lshlrev_b32 v33, 2, v30
  v_lshlrev_b32 v34, 1, v30
  v_cndmask_b32 v33, v34, v33, vcc
  v_lshl_add_u32 v33, v31, 6, v33
  v_lshlrev_b32 v33, 2, v33
  v_add_u32 v33, s7, v33
  v_mov_b32 v34, 128
  v_cndmask_b32 v34, v34, 8, vcc
  v_add_u32 v34, v33, v34
  v_lshl_add_u32 v35, v31, 6, v30
  v_lshlrev_b32 v35, 2, v35
  v_add_u32 v35, s7, v35
  ds_write_b32 v32, v84 offset:0
  ds_write_b32 v32, v85 offset:4
  ds_write_b32 v32, v86 offset:8
  ds_write_b32 v32, v87 offset:12
  ds_write_b32 v33, v88 offset:1024
  ds_write_b32 v33, v89 offset:1028
  ds_write_b32 v34, v90 offset:1024
  ds_write_b32 v34, v91 offset:1028
  s_waitcnt lgkmcnt(11)
  v_mfma_f32_16x16x32_bf16 v[92:95], v[68:71], v[52:55], 0
  s_waitcnt lgkmcnt(10)
  v_mfma_f32_16x16x32_bf16 v[92:95], v[72:75], v[56:59], v[92:95]
  s_waitcnt lgkmcnt(9)
  v_mfma_f32_16x16x32_bf16 v[92:95], v[76:79], v[60:63], v[92:95]
  s_waitcnt lgkmcnt(8)
  v_mfma_f32_16x16x32_bf16 v[92:95], v[80:83], v[64:67], v[92:95]
  s_nop 7
  ds_write_b32 v35, v92 offset:2048
  ds_write_b32 v35, v93 offset:2112
  ds_write_b32 v35, v94 offset:2176
  ds_write_b32 v35, v95 offset:2240
  s_cmp_eq_u32 s64, 0
  s_cbranch_scc0 L_Brest
  s_waitcnt lgkmcnt(0)
  s_lshl_b32 s9, s2, 3
  s_lshl_b32 s8, s63, 1
  s_add_u32 s9, s9, s8
  v_lshlrev_b32 v9, 4, v2
  s_lshl_b32 s8, s9, 11
  v_add_u32 v8, s8, v9
  v_add_u32 v4, 0x800, v8
  global_load_dwordx4 v[224:227], v8, s[16:17] nt
  global_load_dwordx4 v[228:231], v8, s[16:17] offset:1024 nt
  global_load_dwordx4 v[232:235], v4, s[16:17] nt
  global_load_dwordx4 v[236:239], v4, s[16:17] offset:1024 nt
  global_load_dwordx4 v[240:243], v9, s[42:43]
  global_load_dwordx4 v[244:247], v9, s[42:43] offset:1024
  v_lshlrev_b32 v10, 16, v105
  v_mov_b32 v24, 149728
  s_mov_b32 s13, 0
L_lw_kd:
  ds_read_b128 v[20:23], v24
  s_waitcnt lgkmcnt(0)
  v_min_u32 v20, v20, v21
  v_min_u32 v22, v22, v23
  v_min_u32 v20, v20, v22
  s_nop 0
  v_readfirstlane_b32 s7, v20
  s_add_u32 s13, s13, 1
  s_cmp_ge_u32 s7, 1
  s_cbranch_scc1 L_lwd_kd
  s_cmp_lt_u32 s13, 0x400000
  s_cbranch_scc1 L_lw_kd
L_lwd_kd:
  s_mul_i32 s7, s63, 3072
  s_add_u32 s7, s7, 33024
  v_lshlrev_b32 v20, 5, v2
  v_lshlrev_b32 v21, 4, v2
  v_add_u32 v21, 512, v21
  v_cmp_gt_u32 vcc, 32, v2
  s_nop 1
  v_cndmask_b32 v20, v21, v20, vcc
  v_add_u32 v20, s7, v20
  v_lshlrev_b32 v21, 3, v2
  v_add_u32 v21, s7, v21
  v_lshlrev_b32 v22, 2, v2
  v_add_u32 v22, s7, v22
  ds_read_b128 v[32:35], v20 offset:0
  ds_read_b128 v[36:39], v20 offset:16
  ds_read_b64 v[40:41], v21 offset:1536
  ds_read_b32 v42, v21 offset:1544
  ds_read_b32 v44, v22 offset:2048
  ds_read_b32 v45, v22 offset:2052
  ds_read_b32 v46, v22 offset:2304
  ds_read_b32 v47, v22 offset:2308
  ds_read_b128 v[48:51], v20 offset:12288
  ds_read_b128 v[52:55], v20 offset:12304
  ds_read_b64 v[56:57], v21 offset:13824
  ds_read_b32 v58, v21 offset:13832
  ds_read_b32 v60, v22 offset:14336
  ds_read_b32 v61, v22 offset:14340
  ds_read_b32 v62, v22 offset:14592
  ds_read_b32 v63, v22 offset:14596
  v_lshlrev_b32 v23, 4, v2
  s_mul_i32 s8, s63, 4128
  s_add_u32 s8, s8, 32
  v_add_u32 v23, s8, v23
  v_and_b32 v24, 1, v2
  v_cmp_eq_u32 s[14:15], 1, v24
  s_waitcnt lgkmcnt(7)
  v_add_f32 v32, v32, v48
  v_add_f32 v33, v33, v49
  v_add_f32 v34, v34, v50
  v_add_f32 v35, v35, v51
  s_waitcnt lgkmcnt(6)
  v_add_f32 v36, v36, v52
  v_add_f32 v37, v37, v53
  v_add_f32 v38, v38, v54
  v_add_f32 v39, v39, v55
  s_waitcnt lgkmcnt(5)
  v_add_f32 v40, v40, v56
  v_add_f32 v41, v41, v57
  s_waitcnt lgkmcnt(4)
  v_add_f32 v42, v42, v58
  s_waitcnt lgkmcnt(3)
  v_add_f32 v44, v44, v60
  s_waitcnt lgkmcnt(2)
  v_add_f32 v45, v45, v61
  s_waitcnt lgkmcnt(1)
  v_add_f32 v46, v46, v62
  s_waitcnt lgkmcnt(0)
  v_add_f32 v47, v47, v63
  v_mov_b32 v48, v32
  v_cndmask_b32 v49, v32, v33, vcc
  v_cndmask_b32 v50, v33, v34, vcc
  v_cndmask_b32 v51, v34, v35, vcc
  v_cndmask_b32 v52, v34, v36, vcc
  v_cndmask_b32 v53, v34, v37, vcc
  v_cndmask_b32 v54, v35, v38, vcc
  v_cndmask_b32 v55, v36, v39, vcc
  v_cvt_pk_bf16_f32 v56, v48, v49
  v_cvt_pk_bf16_f32 v57, v50, v51
  v_cvt_pk_bf16_f32 v58, v52, v53
  v_cvt_pk_bf16_f32 v59, v54, v55
  ds_write_b128 v23, v[56:59]
  s_nop 1
  v_cvt_pk_bf16_f32 v56, v40, v40
  v_cvt_pk_bf16_f32 v57, v40, v41
  v_cvt_pk_bf16_f32 v58, v41, v41
  v_cvt_pk_bf16_f32 v59, v42, v42
  s_nop 0
  ds_write_b128 v23, v[56:59] offset:1024
  v_cndmask_b32 v52, v44, v45, s[14:15]
  v_cvt_pk_bf16_f32 v60, v44, v44
  v_cvt_pk_bf16_f32 v61, v44, v44
  v_cvt_pk_bf16_f32 v62, v52, v45
  v_cvt_pk_bf16_f32 v63, v45, v45
  ds_write_b128 v23, v[60:63] offset:2048
  v_cndmask_b32 v52, v46, v47, s[14:15]
  v_cvt_pk_bf16_f32 v48, v46, v46
  v_cvt_pk_bf16_f32 v49, v46, v46
  v_cvt_pk_bf16_f32 v50, v52, v47
  v_cvt_pk_bf16_f32 v51, v47, v47
  ds_write_b128 v23, v[48:51] offset:3072
  v_mov_b32 v16, 0
  v_mov_b32 v17, 0
  v_mov_b32 v18, 0
  v_mov_b32 v19, 0
  v_bfe_u32 v20, v2, 3, 2
  v_mul_u32_u24 v20, 1168, v20
  v_and_b32 v21, 7, v2
  v_lshl_add_u32 v20, v21, 4, v20
  s_mul_i32 s7, s63, 4672
  s_add_u32 s7, s7, 131008
  v_add_u32 v20, s7, v20
  ds_write_b128 v20, v[16:19]
  v_and_b32 v24, 3, v2
  v_bfe_u32 v25, v2, 2, 2
  v_sub_u32 v24, v24, v25
  v_lshlrev_b32 v24, 3, v24
  v_lshrrev_b32 v25, 4, v2
  v_lshlrev_b32 v25, 6, v25
  v_sub_u32 v24, v24, v25
  s_mul_i32 s7, s6, 4128
  s_add_u32 s7, s7, 224
  v_add_u32 v24, s7, v24
  ds_read_b64_tr_b16 v[64:65], v24 offset:32
  ds_read_b64_tr_b16 v[66:67], v24 offset:0
  ds_read_b64_tr_b16 v[68:69], v24 offset:288
  ds_read_b64_tr_b16 v[70:71], v24 offset:256
  ds_read_b64_tr_b16 v[72:73], v24 offset:544
  ds_read_b64_tr_b16 v[74:75], v24 offset:512
  ds_read_b64_tr_b16 v[76:77], v24 offset:800
  ds_read_b64_tr_b16 v[78:79], v24 offset:768
  ds_read_b64_tr_b16 v[80:81], v24 offset:1056
  ds_read_b64_tr_b16 v[82:83], v24 offset:1024
  ds_read_b64_tr_b16 v[84:85], v24 offset:1312
  ds_read_b64_tr_b16 v[86:87], v24 offset:1280
  ds_read_b64_tr_b16 v[88:89], v24 offset:1568
  ds_read_b64_tr_b16 v[90:91], v24 offset:1536
  ds_read_b64_tr_b16 v[92:93], v24 offset:1824
  ds_read_b64_tr_b16 v[94:95], v24 offset:1792
  ds_read_b64_tr_b16 v[96:97], v24 offset:2080
  ds_read_b64_tr_b16 v[98:99], v24 offset:2048
  ds_read_b64_tr_b16 v[100:101], v24 offset:2336
  ds_read_b64_tr_b16 v[102:103], v24 offset:2304
  ds_read_b64_tr_b16 v[104:105], v24 offset:2592
  ds_read_b64_tr_b16 v[106:107], v24 offset:2560
  ds_read_b64_tr_b16 v[108:109], v24 offset:2848
  ds_read_b64_tr_b16 v[110:111], v24 offset:2816
  ds_read_b64_tr_b16 v[112:113], v24 offset:3104
  ds_read_b64_tr_b16 v[114:115], v24 offset:3072
  ds_read_b64_tr_b16 v[116:117], v24 offset:3360
  ds_read_b64_tr_b16 v[118:119], v24 offset:3328
  ds_read_b64_tr_b16 v[120:121], v24 offset:3616
  ds_read_b64_tr_b16 v[122:123], v24 offset:3584
  ds_read_b64_tr_b16 v[124:125], v24 offset:3872
  ds_read_b64_tr_b16 v[126:127], v24 offset:3840
  s_cmp_eq_u32 s63, 0
  s_cbranch_scc0 L_pwx
  s_lshl_b32 s7, s4, 1
  s_lshl_b32 s7, s7, 10
  v_lshlrev_b32 v3, 4, v2
  v_add_u32 v3, s7, v3
  s_mov_b32 s13, 0
L_pollx:
  global_load_dword v4, v3, s[48:49] sc1
  s_waitcnt vmcnt(0)
  v_cmp_ne_u32 vcc, s74, v4
  s_cbranch_vccz L_polledx
  s_add_u32 s13, s13, 1
  s_cmp_lt_u32 s13, 0x40000
  s_cbranch_scc0 L_polledx
  s_sleep 2
  s_branch L_pollx
L_polledx:
  v_mov_b32 v3, 149744
  v_mov_b32 v20, 1
  v_mov_b32 v21, 1
  v_mov_b32 v22, 1
  v_mov_b32 v23, 1
  ds_write_b128 v3, v[20:23]
  s_branch L_pdx
L_pwx:
  v_mov_b32 v24, 149744
  s_mov_b32 s13, 0
L_lw_px:
  ds_read_b128 v[20:23], v24
  s_waitcnt lgkmcnt(0)
  v_min_u32 v20, v20, v21
  v_min_u32 v22, v22, v23
  v_min_u32 v20, v20, v22
  s_nop 0
  v_readfirstlane_b32 s7, v20
  s_add_u32 s13, s13, 1
  s_cmp_ge_u32 s7, 1
  s_cbranch_scc1 L_lwd_px
  s_cmp_lt_u32 s13, 0x400000
  s_cbranch_scc1 L_lw_px
L_lwd_px:
L_pdx:
  s_waitcnt lgkmcnt(0)
  s_lshl_b32 s7, s4, 18
  s_lshl_b32 s8, s5, 14
  s_add_u32 s7, s7, s8
  s_lshl_b32 s8, s63, 12
  s_add_u32 s7, s7, s8
  s_add_u32 s7, s7, 1048576
  s_add_u32 s68, s48, s7
  s_addc_u32 s69, s49, 0
  v_lshlrev_b32 v3, 4, v2
  global_load_dwordx4 v[128:131], v3, s[68:69] offset:0 sc1
  global_load_dwordx4 v[132:135], v3, s[68:69] offset:1024 sc1
  global_load_dwordx4 v[136:139], v3, s[68:69] offset:2048 sc1
  global_load_dwordx4 v[140:143], v3, s[68:69] offset:3072 sc1
  s_mul_i32 s7, s63, 4672
  s_add_u32 s7, s7, 131136
  v_and_b32 v6, 3, v2
  v_mul_u32_u24 v6, 1168, v6
  v_lshrrev_b32 v3, 4, v2
  v_lshl_add_u32 v6, v3, 6, v6
  v_bfe_u32 v3, v2, 2, 2
  v_lshl_add_u32 v6, v3, 4, v6
  v_add_u32 v6, s7, v6
  s_waitcnt vmcnt(4)
  v_mov_b32 v172, 0
  v_mov_b32 v173, 0
  v_mov_b32 v174, 0x3f803f80
  v_lshlrev_b32 v176, 16, v240
  v_and_b32 v177, 0xffff0000, v240
  v_lshlrev_b32 v178, 16, v224
  v_and_b32 v179, 0xffff0000, v224
  v_mul_f32 v178, v178, v176
  v_mul_f32 v179, v179, v177
  v_cvt_pk_bf16_f32 v178, v178, v179
  v_dot2c_f32_bf16 v172, v178, v174
  v_lshlrev_b32 v180, 16, v232
  v_and_b32 v181, 0xffff0000, v232
  v_mul_f32 v180, v180, v176
  v_mul_f32 v181, v181, v177
  v_cvt_pk_bf16_f32 v180, v180, v181
  v_dot2c_f32_bf16 v173, v180, v174
  v_lshlrev_b32 v176, 16, v241
  v_and_b32 v177, 0xffff0000, v241
  v_lshlrev_b32 v178, 16, v225
  v_and_b32 v179, 0xffff0000, v225
  v_mul_f32 v178, v178, v176
  v_mul_f32 v179, v179, v177
  v_cvt_pk_bf16_f32 v178, v178, v179
  v_dot2c_f32_bf16 v172, v178, v174
  v_lshlrev_b32 v180, 16, v233
  v_and_b32 v181, 0xffff0000, v233
  v_mul_f32 v180, v180, v176
  v_mul_f32 v181, v181, v177
  v_cvt_pk_bf16_f32 v180, v180, v181
  v_dot2c_f32_bf16 v173, v180, v174
  v_lshlrev_b32 v176, 16, v242
  v_and_b32 v177, 0xffff0000, v242
  v_lshlrev_b32 v178, 16, v226
  v_and_b32 v179, 0xffff0000, v226
  v_mul_f32 v178, v178, v176
  v_mul_f32 v179, v179, v177
  v_cvt_pk_bf16_f32 v178, v178, v179
  v_dot2c_f32_bf16 v172, v178, v174
  v_lshlrev_b32 v180, 16, v234
  v_and_b32 v181, 0xffff0000, v234
  v_mul_f32 v180, v180, v176
  v_mul_f32 v181, v181, v177
  v_cvt_pk_bf16_f32 v180, v180, v181
  v_dot2c_f32_bf16 v173, v180, v174
  v_lshlrev_b32 v176, 16, v243
  v_and_b32 v177, 0xffff0000, v243
  v_lshlrev_b32 v178, 16, v227
  v_and_b32 v179, 0xffff0000, v227
  v_mul_f32 v178, v178, v176
  v_mul_f32 v179, v179, v177
  v_cvt_pk_bf16_f32 v178, v178, v179
  v_dot2c_f32_bf16 v172, v178, v174
  v_lshlrev_b32 v180, 16, v235
  v_and_b32 v181, 0xffff0000, v235
  v_mul_f32 v180, v180, v176
  v_mul_f32 v181, v181, v177
  v_cvt_pk_bf16_f32 v180, v180, v181
  v_dot2c_f32_bf16 v173, v180, v174
  v_lshlrev_b32 v176, 16, v244
  v_and_b32 v177, 0xffff0000, v244
  v_lshlrev_b32 v178, 16, v228
  v_and_b32 v179, 0xffff0000, v228
  v_mul_f32 v178, v178, v176
  v_mul_f32 v179, v179, v177
  v_cvt_pk_bf16_f32 v178, v178, v179
  v_dot2c_f32_bf16 v172, v178, v174
  v_lshlrev_b32 v180, 16, v236
  v_and_b32 v181, 0xffff0000, v236
  v_mul_f32 v180, v180, v176
  v_mul_f32 v181, v181, v177
  v_cvt_pk_bf16_f32 v180, v180, v181
  v_dot2c_f32_bf16 v173, v180, v174
  v_lshlrev_b32 v176, 16, v245
  v_and_b32 v177, 0xffff0000, v245
  v_lshlrev_b32 v178, 16, v229
  v_and_b32 v179, 0xffff0000, v229
  v_mul_f32 v178, v178, v176
  v_mul_f32 v179, v179, v177
  v_cvt_pk_bf16_f32 v178, v178, v179
  v_dot2c_f32_bf16 v172, v178, v174
  v_lshlrev_b32 v180, 16, v237
  v_and_b32 v181, 0xffff0000, v237
  v_mul_f32 v180, v180, v176
  v_mul_f32 v181, v181, v177
  v_cvt_pk_bf16_f32 v180, v180, v181
  v_dot2c_f32_bf16 v173, v180, v174
  v_lshlrev_b32 v176, 16, v246
  v_and_b32 v177, 0xffff0000, v246
  v_lshlrev_b32 v178, 16, v230
  v_and_b32 v179, 0xffff0000, v230
  v_mul_f32 v178, v178, v176
  v_mul_f32 v179, v179, v177
  v_cvt_pk_bf16_f32 v178, v178, v179
  v_dot2c_f32_bf16 v172, v178, v174
  v_lshlrev_b32 v180, 16, v238
  v_and_b32 v181, 0xffff0000, v238
  v_mul_f32 v180, v180, v176
  v_mul_f32 v181, v181, v177
  v_cvt_pk_bf16_f32 v180, v180, v181
  v_dot2c_f32_bf16 v173, v180, v174
  v_lshlrev_b32 v176, 16, v247
  v_and_b32 v177, 0xffff0000, v247
  v_lshlrev_b32 v178, 16, v231
  v_and_b32 v179, 0xffff0000, v231
  v_mul_f32 v178, v178, v176
  v_mul_f32 v179, v179, v177
  v_cvt_pk_bf16_f32 v178, v178, v179
  v_dot2c_f32_bf16 v172, v178, v174
  v_lshlrev_b32 v180, 16, v239
  v_and_b32 v181, 0xffff0000, v239
  v_mul_f32 v180, v180, v176
  v_mul_f32 v181, v181, v177
  v_cvt_pk_bf16_f32 v180, v180, v181
  v_dot2c_f32_bf16 v173, v180, v174
  v_add_f32_dpp v172, v172, v172 quad_perm:[1,0,3,2] row_mask:0xf bank_mask:0xf
  s_nop 1
  v_add_f32_dpp v173, v173, v173 quad_perm:[1,0,3,2] row_mask:0xf bank_mask:0xf
  v_add_f32_dpp v172, v172, v172 quad_perm:[2,3,0,1] row_mask:0xf bank_mask:0xf
  s_nop 0
  v_add_f32_dpp v173, v173, v173 quad_perm:[2,3,0,1] row_mask:0xf bank_mask:0xf
  v_add_f32_dpp v172, v172, v172 row_half_mirror row_mask:0xf bank_mask:0xf
  s_nop 0
  v_add_f32_dpp v173, v173, v173 row_half_mirror row_mask:0xf bank_mask:0xf
  v_add_f32_dpp v172, v172, v172 row_mirror row_mask:0xf bank_mask:0xf
  s_nop 0
  v_add_f32_dpp v173, v173, v173 row_mirror row_mask:0xf bank_mask:0xf
  v_readlane_b32 s50, v172, 0
  v_readlane_b32 s51, v172, 16
  v_readlane_b32 s52, v172, 32
  v_readlane_b32 s53, v172, 48
  v_readlane_b32 s54, v173, 0
  v_readlane_b32 s55, v173, 16
  v_readlane_b32 s56, v173, 32
  v_readlane_b32 s57, v173, 48
  v_mov_b32 v176, s50
  v_add_f32 v176, s51, v176
  v_add_f32 v176, s52, v176
  v_add_f32 v176, s53, v176
  v_mov_b32 v177, s54
  v_add_f32 v177, s55, v177
  v_add_f32 v177, s56, v177
  v_add_f32 v177, s57, v177
  v_cmp_eq_u32 vcc, 1, v2
  s_nop 1
  v_cndmask_b32 v176, v176, v177, vcc
  v_cvt_pk_bf16_f32 v176, v176, v176
  v_and_b32 v176, 0xffff0000, v176
  v_mul_f32 v176, 0xbfb8aa3b, v176
  v_exp_f32 v176, v176
  s_nop 0
  v_add_f32 v176, 1.0, v176
  v_rcp_f32 v176, v176
  s_nop 0
  v_cvt_pk_bf16_f32 v176, v176, v176
  v_and_b32 v176, 0xffff0000, v176
  v_mov_b32 v177, s74
  s_lshl_b32 s56, s9, 3
  s_add_u32 s56, s56, 131072
  v_lshlrev_b32 v180, 3, v2
  v_add_u32 v180, s56, v180
  s_mov_b64 exec, 3
  global_store_dwordx2 v180, v[176:177], s[48:49] sc1
  s_mov_b64 exec, -1
  v_and_b32 v20, 15, v2
  v_lshrrev_b32 v21, 4, v2
  s_mul_i32 s7, s63, 4672
  s_add_u32 s8, s7, 131016
  v_lshlrev_b32 v3, 3, v20
  v_lshl_add_u32 v3, v21, 4, v3
  v_add_u32 v3, s8, v3
  s_add_u32 s8, s7, 131136
  v_lshlrev_b32 v4, 3, v20
  v_lshl_add_u32 v4, v21, 1, v4
  v_add_u32 v4, s8, v4
  s_lshl_b32 s8, s63, 1
  s_add_u32 s8, s8, 92416
  v_mul_u32_u24 v5, 576, v21
  v_lshl_add_u32 v5, v20, 3, v5
  v_add_u32 v5, s8, v5
  v_subrev_u32 v7, 16, v2
  v_add_u32 v23, 47, v2
  v_cmp_gt_u32 vcc, 16, v2
  s_nop 1
  v_cndmask_b32 v7, v7, v23, vcc
  v_cmp_eq_u32 s[70:71], 0, v2
  v_mov_b32 v23, 63
  s_nop 0
  v_cndmask_b32 v7, v7, v23, s[70:71]
  v_lshlrev_b32 v7, 2, v7
  v_mov_b32 v12, 0
  v_mov_b32 v13, 0
  v_mov_b32 v14, 0
  v_mov_b32 v15, 0
  v_mov_b32 v16, 0
  v_mov_b32 v17, 0
  v_mov_b32 v18, 0
  v_mov_b32 v19, 0
  v_mov_b32 v27, 0
  v_mov_b32 v28, 0
  v_mov_b32 v29, 0
  v_mov_b32 v30, 0
  v_mov_b32 v31, 0
  v_mov_b32 v11, 0
  s_waitcnt vmcnt(1)
  ds_write_b128 v6, v[128:131] offset:0
  ds_write_b128 v6, v[132:135] offset:256
  ds_write_b128 v6, v[136:139] offset:512
  ds_write_b128 v6, v[140:143] offset:768
  s_waitcnt lgkmcnt(0)
  s_lshl_b32 s7, s6, 2
  s_add_u32 s7, s7, 149696
  v_mov_b32 v20, s7
  v_mov_b32 v21, 1
  ds_write_b32 v20, v21
  v_mov_b32 v24, 149712
  s_mov_b32 s13, 0
L_lw_a1b:
  ds_read_b128 v[20:23], v24
  s_waitcnt lgkmcnt(0)
  v_min_u32 v20, v20, v21
  v_min_u32 v22, v22, v23
  v_min_u32 v20, v20, v22
  s_nop 0
  v_readfirstlane_b32 s7, v20
  s_add_u32 s13, s13, 1
  s_cmp_ge_u32 s7, 1
  s_cbranch_scc1 L_lwd_a1b
  s_cmp_lt_u32 s13, 0x400000
  s_cbranch_scc1 L_lw_a1b
L_lwd_a1b:
  s_setprio 2
  ds_read_b64 v[32:33], v3 offset:0
  ds_read_b64 v[34:35], v3 offset:8
  ds_read_b64 v[36:37], v3 offset:1168
  ds_read_b64 v[38:39], v3 offset:1176
  ds_read_b64 v[40:41], v3 offset:2336
  ds_read_b64 v[42:43], v3 offset:2344
  ds_read_b64 v[44:45], v3 offset:3504
  ds_read_b64 v[46:47], v3 offset:3512
  s_waitcnt lgkmcnt(6)
  v_mfma_f32_16x16x32_bf16 v[128:131], v[68:71], v[32:35], 0
  ds_read_b64 v[48:49], v3 offset:64
  ds_read_b64 v[50:51], v3 offset:72
  v_mfma_f32_16x16x32_bf16 v[144:147], v[76:79], v[32:35], 0
  ds_read_b64 v[52:53], v3 offset:1232
  ds_read_b64 v[54:55], v3 offset:1240
  v_mfma_f32_16x16x32_bf16 v[160:163], v[84:87], v[32:35], 0
  ds_read_b64 v[56:57], v3 offset:2400
  ds_read_b64 v[58:59], v3 offset:2408
  v_mfma_f32_16x16x32_bf16 v[176:179], v[92:95], v[32:35], 0
  ds_read_b64 v[60:61], v3 offset:3568
  ds_read_b64 v[62:63], v3 offset:3576
  v_mfma_f32_16x16x32_bf16 v[192:195], v[100:103], v[32:35], 0
  v_mfma_f32_16x16x32_bf16 v[208:211], v[108:111], v[32:35], 0
  v_mfma_f32_16x16x32_bf16 v[224:227], v[116:119], v[32:35], 0
  v_mfma_f32_16x16x32_bf16 v[240:243], v[124:127], v[32:35], 0
  s_waitcnt lgkmcnt(12)
  v_mfma_f32_16x16x32_bf16 v[132:135], v[68:71], v[36:39], 0
  v_mfma_f32_16x16x32_bf16 v[148:151], v[76:79], v[36:39], 0
  v_mfma_f32_16x16x32_bf16 v[164:167], v[84:87], v[36:39], 0
  v_mfma_f32_16x16x32_bf16 v[180:183], v[92:95], v[36:39], 0
  v_mfma_f32_16x16x32_bf16 v[196:199], v[100:103], v[36:39], 0
  v_mfma_f32_16x16x32_bf16 v[212:215], v[108:111], v[36:39], 0
  v_mfma_f32_16x16x32_bf16 v[228:231], v[116:119], v[36:39], 0
  v_mfma_f32_16x16x32_bf16 v[244:247], v[124:127], v[36:39], 0
  s_waitcnt lgkmcnt(10)
  v_mfma_f32_16x16x32_bf16 v[136:139], v[68:71], v[40:43], 0
  v_mfma_f32_16x16x32_bf16 v[152:155], v[76:79], v[40:43], 0
  v_mfma_f32_16x16x32_bf16 v[168:171], v[84:87], v[40:43], 0
  v_mfma_f32_16x16x32_bf16 v[184:187], v[92:95], v[40:43], 0
  v_mfma_f32_16x16x32_bf16 v[200:203], v[100:103], v[40:43], 0
  v_mfma_f32_16x16x32_bf16 v[216:219], v[108:111], v[40:43], 0
  v_mfma_f32_16x16x32_bf16 v[232:235], v[116:119], v[40:43], 0
  v_mfma_f32_16x16x32_bf16 v[248:251], v[124:127], v[40:43], 0
  s_waitcnt lgkmcnt(8)
  v_mfma_f32_16x16x32_bf16 v[140:143], v[68:71], v[44:47], 0
  v_mfma_f32_16x16x32_bf16 v[156:159], v[76:79], v[44:47], 0
  v_mfma_f32_16x16x32_bf16 v[172:175], v[84:87], v[44:47], 0
  v_mfma_f32_16x16x32_bf16 v[188:191], v[92:95], v[44:47], 0
  v_mfma_f32_16x16x32_bf16 v[204:207], v[100:103], v[44:47], 0
  v_mfma_f32_16x16x32_bf16 v[220:223], v[108:111], v[44:47], 0
  v_mfma_f32_16x16x32_bf16 v[236:239], v[116:119], v[44:47], 0
  v_mfma_f32_16x16x32_bf16 v[252:255], v[124:127], v[44:47], 0
  s_waitcnt lgkmcnt(6)
  v_mfma_f32_16x16x32_bf16 v[128:131], v[64:67], v[48:51], v[128:131]
  ds_read_b64 v[32:33], v3 offset:128
  ds_read_b64 v[34:35], v3 offset:136
  v_mfma_f32_16x16x32_bf16 v[144:147], v[72:75], v[48:51], v[144:147]
  ds_read_b64 v[36:37], v3 offset:1296
  ds_read_b64 v[38:39], v3 offset:1304
  v_mfma_f32_16x16x32_bf16 v[160:163], v[80:83], v[48:51], v[160:163]
  ds_read_b64 v[40:41], v3 offset:2464
  ds_read_b64 v[42:43], v3 offset:2472
  v_mfma_f32_16x16x32_bf16 v[176:179], v[88:91], v[48:51], v[176:179]
  ds_read_b64 v[44:45], v3 offset:3632
  ds_read_b64 v[46:47], v3 offset:3640
  v_mfma_f32_16x16x32_bf16 v[192:195], v[96:99], v[48:51], v[192:195]
  v_mfma_f32_16x16x32_bf16 v[208:211], v[104:107], v[48:51], v[208:211]
  v_mfma_f32_16x16x32_bf16 v[224:227], v[112:115], v[48:51], v[224:227]
  v_mfma_f32_16x16x32_bf16 v[240:243], v[120:123], v[48:51], v[240:243]
  s_waitcnt lgkmcnt(12)
  v_mfma_f32_16x16x32_bf16 v[132:135], v[64:67], v[52:55], v[132:135]
  v_mfma_f32_16x16x32_bf16 v[148:151], v[72:75], v[52:55], v[148:151]
  v_mfma_f32_16x16x32_bf16 v[164:167], v[80:83], v[52:55], v[164:167]
  v_mfma_f32_16x16x32_bf16 v[180:183], v[88:91], v[52:55], v[180:183]
  v_mfma_f32_16x16x32_bf16 v[196:199], v[96:99], v[52:55], v[196:199]
  v_mfma_f32_16x16x32_bf16 v[212:215], v[104:107], v[52:55], v[212:215]
  v_mfma_f32_16x16x32_bf16 v[228:231], v[112:115], v[52:55], v[228:231]
  v_mfma_f32_16x16x32_bf16 v[244:247], v[120:123], v[52:55], v[244:247]
  s_waitcnt lgkmcnt(10)
  v_mfma_f32_16x16x32_bf16 v[136:139], v[64:67], v[56:59], v[136:139]
  v_mfma_f32_16x16x32_bf16 v[152:155], v[72:75], v[56:59], v[152:155]
  v_mfma_f32_16x16x32_bf16 v[168:171], v[80:83], v[56:59], v[168:171]
  v_mfma_f32_16x16x32_bf16 v[184:187], v[88:91], v[56:59], v[184:187]
  v_mfma_f32_16x16x32_bf16 v[200:203], v[96:99], v[56:59], v[200:203]
  v_mfma_f32_16x16x32_bf16 v[216:219], v[104:107], v[56:59], v[216:219]
  v_mfma_f32_16x16x32_bf16 v[232:235], v[112:115], v[56:59], v[232:235]
  v_mfma_f32_16x16x32_bf16 v[248:251], v[120:123], v[56:59], v[248:251]
  s_waitcnt lgkmcnt(8)
  v_mfma_f32_16x16x32_bf16 v[140:143], v[64:67], v[60:63], v[140:143]
  v_mfma_f32_16x16x32_bf16 v[156:159], v[72:75], v[60:63], v[156:159]
  v_mfma_f32_16x16x32_bf16 v[172:175], v[80:83], v[60:63], v[172:175]
  v_mfma_f32_16x16x32_bf16 v[188:191], v[88:91], v[60:63], v[188:191]
  v_mfma_f32_16x16x32_bf16 v[204:207], v[96:99], v[60:63], v[204:207]
  v_mfma_f32_16x16x32_bf16 v[220:223], v[104:107], v[60:63], v[220:223]
  v_mfma_f32_16x16x32_bf16 v[236:239], v[112:115], v[60:63], v[236:239]
  v_mfma_f32_16x16x32_bf16 v[252:255], v[120:123], v[60:63], v[252:255]
  s_waitcnt lgkmcnt(6)
  v_mfma_f32_16x16x32_bf16 v[144:147], v[68:71], v[32:35], v[144:147]
  ds_read_b64 v[48:49], v3 offset:192
  ds_read_b64 v[50:51], v3 offset:200
  v_mfma_f32_16x16x32_bf16 v[160:163], v[76:79], v[32:35], v[160:163]
  ds_read_b64 v[52:53], v3 offset:1360
  ds_read_b64 v[54:55], v3 offset:1368
  v_mfma_f32_16x16x32_bf16 v[176:179], v[84:87], v[32:35], v[176:179]
  ds_read_b64 v[56:57], v3 offset:2528
  ds_read_b64 v[58:59], v3 offset:2536
  v_mfma_f32_16x16x32_bf16 v[192:195], v[92:95], v[32:35], v[192:195]
  ds_read_b64 v[60:61], v3 offset:3696
  ds_read_b64 v[62:63], v3 offset:3704
  v_mfma_f32_16x16x32_bf16 v[208:211], v[100:103], v[32:35], v[208:211]
  ds_read_u16_d16_hi v12, v4 offset:0
  ds_read_u16_d16_hi v13, v4 offset:1168
  v_mfma_f32_16x16x32_bf16 v[224:227], v[108:111], v[32:35], v[224:227]
  ds_read_u16_d16_hi v14, v4 offset:2336
  ds_read_u16_d16_hi v15, v4 offset:3504
  v_mfma_f32_16x16x32_bf16 v[240:243], v[116:119], v[32:35], v[240:243]
  v_add_f32 v24, v135, v138
  v_add_f32 v25, v139, v142
  s_waitcnt lgkmcnt(15)
  v_mfma_f32_16x16x32_bf16 v[148:151], v[68:71], v[36:39], v[148:151]
  v_add_f32 v24, v24, v141
  ds_bpermute_b32 v31, v7, v25
  v_mfma_f32_16x16x32_bf16 v[164:167], v[76:79], v[36:39], v[164:167]
  ds_bpermute_b32 v11, v7, v143
  ds_bpermute_b32 v30, v7, v24
  v_mfma_f32_16x16x32_bf16 v[180:183], v[84:87], v[36:39], v[180:183]
  v_add_f32 v21, v129, v132
  v_add_f32 v22, v130, v133
  v_mfma_f32_16x16x32_bf16 v[196:199], v[92:95], v[36:39], v[196:199]
  v_add_f32 v23, v131, v134
  v_add_f32 v22, v22, v136
  v_mfma_f32_16x16x32_bf16 v[212:215], v[100:103], v[36:39], v[212:215]
  v_add_f32 v23, v23, v137
  v_add_f32 v23, v23, v140
  v_mfma_f32_16x16x32_bf16 v[228:231], v[108:111], v[36:39], v[228:231]
  v_mfma_f32_16x16x32_bf16 v[244:247], v[116:119], v[36:39], v[244:247]
  s_waitcnt lgkmcnt(15)
  v_mfma_f32_16x16x32_bf16 v[152:155], v[68:71], v[40:43], v[152:155]
  v_mfma_f32_16x16x32_bf16 v[168:171], v[76:79], v[40:43], v[168:171]
  v_mfma_f32_16x16x32_bf16 v[184:187], v[84:87], v[40:43], v[184:187]
  v_mfma_f32_16x16x32_bf16 v[200:203], v[92:95], v[40:43], v[200:203]
  s_waitcnt lgkmcnt(0)
  v_cndmask_b32 v24, v30, v27, s[70:71]
  v_cndmask_b32 v25, v31, v28, s[70:71]
  v_mfma_f32_16x16x32_bf16 v[216:219], v[100:103], v[40:43], v[216:219]
  v_cndmask_b32 v26, v11, v29, s[70:71]
  v_add_f32 v20, v128, v24
  v_mfma_f32_16x16x32_bf16 v[232:235], v[108:111], v[40:43], v[232:235]
  v_add_f32 v21, v21, v25
  v_add_f32 v22, v22, v26
  v_mfma_f32_16x16x32_bf16 v[248:251], v[116:119], v[40:43], v[248:251]
  v_cvt_pk_bf16_f32 v24, v20, v21
  v_cvt_pk_bf16_f32 v25, v22, v23
  v_mfma_f32_16x16x32_bf16 v[156:159], v[68:71], v[44:47], v[156:159]
  v_lshlrev_b32 v20, 16, v24
  v_and_b32 v21, 0xffff0000, v24
  v_mfma_f32_16x16x32_bf16 v[172:175], v[76:79], v[44:47], v[172:175]
  v_lshlrev_b32 v22, 16, v25
  v_and_b32 v23, 0xffff0000, v25
  v_mfma_f32_16x16x32_bf16 v[188:191], v[84:87], v[44:47], v[188:191]
  v_fmac_f32 v20, v12, v10
  v_fmac_f32 v21, v13, v10
  v_mfma_f32_16x16x32_bf16 v[204:207], v[92:95], v[44:47], v[204:207]
  v_fmac_f32 v22, v14, v10
  v_fmac_f32 v23, v15, v10
  v_mfma_f32_16x16x32_bf16 v[220:223], v[100:103], v[44:47], v[220:223]
  v_cvt_pk_bf16_f32 v24, v20, v21
  v_cvt_pk_bf16_f32 v25, v22, v23
  v_mfma_f32_16x16x32_bf16 v[236:239], v[108:111], v[44:47], v[236:239]
  ds_write_b16 v5, v24 offset:0
  ds_write_b16_d16_hi v5, v24 offset:144
  v_mfma_f32_16x16x32_bf16 v[252:255], v[116:119], v[44:47], v[252:255]
  ds_write_b16 v5, v25 offset:288
  ds_write_b16_d16_hi v5, v25 offset:432
  v_mfma_f32_16x16x32_bf16 v[144:147], v[64:67], v[48:51], v[144:147]
  ds_read_b64 v[32:33], v3 offset:256
  ds_read_b64 v[34:35], v3 offset:264
  v_mfma_f32_16x16x32_bf16 v[160:163], v[72:75], v[48:51], v[160:163]
  ds_read_b64 v[36:37], v3 offset:1424
  ds_read_b64 v[38:39], v3 offset:1432
  v_mfma_f32_16x16x32_bf16 v[176:179], v[80:83], v[48:51], v[176:179]
  ds_read_b64 v[40:41], v3 offset:2592
  ds_read_b64 v[42:43], v3 offset:2600
  v_mfma_f32_16x16x32_bf16 v[192:195], v[88:91], v[48:51], v[192:195]
  ds_read_b64 v[44:45], v3 offset:3760
  ds_read_b64 v[46:47], v3 offset:3768
  v_mfma_f32_16x16x32_bf16 v[208:211], v[96:99], v[48:51], v[208:211]
  v_mfma_f32_16x16x32_bf16 v[224:227], v[104:107], v[48:51], v[224:227]
  v_mfma_f32_16x16x32_bf16 v[240:243], v[112:115], v[48:51], v[240:243]
  v_mfma_f32_16x16x32_bf16 v[148:151], v[64:67], v[52:55], v[148:151]
  v_mfma_f32_16x16x32_bf16 v[164:167], v[72:75], v[52:55], v[164:167]
  v_mfma_f32_16x16x32_bf16 v[180:183], v[80:83], v[52:55], v[180:183]
  v_mfma_f32_16x16x32_bf16 v[196:199], v[88:91], v[52:55], v[196:199]
  v_mfma_f32_16x16x32_bf16 v[212:215], v[96:99], v[52:55], v[212:215]
  v_mfma_f32_16x16x32_bf16 v[228:231], v[104:107], v[52:55], v[228:231]
  v_mfma_f32_16x16x32_bf16 v[244:247], v[112:115], v[52:55], v[244:247]
  v_mfma_f32_16x16x32_bf16 v[152:155], v[64:67], v[56:59], v[152:155]
  v_mfma_f32_16x16x32_bf16 v[168:171], v[72:75], v[56:59], v[168:171]
  v_mfma_f32_16x16x32_bf16 v[184:187], v[80:83], v[56:59], v[184:187]
  v_mfma_f32_16x16x32_bf16 v[200:203], v[88:91], v[56:59], v[200:203]
  v_mfma_f32_16x16x32_bf16 v[216:219], v[96:99], v[56:59], v[216:219]
  v_mfma_f32_16x16x32_bf16 v[232:235], v[104:107], v[56:59], v[232:235]
  v_mfma_f32_16x16x32_bf16 v[248:251], v[112:115], v[56:59], v[248:251]
  v_mfma_f32_16x16x32_bf16 v[156:159], v[64:67], v[60:63], v[156:159]
  v_mfma_f32_16x16x32_bf16 v[172:175], v[72:75], v[60:63], v[172:175]
  v_mfma_f32_16x16x32_bf16 v[188:191], v[80:83], v[60:63], v[188:191]
  v_mfma_f32_16x16x32_bf16 v[204:207], v[88:91], v[60:63], v[204:207]
  v_mfma_f32_16x16x32_bf16 v[220:223], v[96:99], v[60:63], v[220:223]
  v_mfma_f32_16x16x32_bf16 v[236:239], v[104:107], v[60:63], v[236:239]
  v_mfma_f32_16x16x32_bf16 v[252:255], v[112:115], v[60:63], v[252:255]
  s_waitcnt lgkmcnt(6)
  v_mfma_f32_16x16x32_bf16 v[160:163], v[68:71], v[32:35], v[160:163]
  ds_read_b64 v[48:49], v3 offset:320
  ds_read_b64 v[50:51], v3 offset:328
  v_mfma_f32_16x16x32_bf16 v[176:179], v[76:79], v[32:35], v[176:179]
  ds_read_b64 v[52:53], v3 offset:1488
  ds_read_b64 v[54:55], v3 offset:1496
  v_mfma_f32_16x16x32_bf16 v[192:195], v[84:87], v[32:35], v[192:195]
  ds_read_b64 v[56:57], v3 offset:2656
  ds_read_b64 v[58:59], v3 offset:2664
  v_mfma_f32_16x16x32_bf16 v[208:211], v[92:95], v[32:35], v[208:211]
  ds_read_b64 v[60:61], v3 offset:3824
  ds_read_b64 v[62:63], v3 offset:3832
  v_mfma_f32_16x16x32_bf16 v[224:227], v[100:103], v[32:35], v[224:227]
  ds_read_u16_d16_hi v12, v4 offset:128
  ds_read_u16_d16_hi v13, v4 offset:1296
  v_mfma_f32_16x16x32_bf16 v[240:243], v[108:111], v[32:35], v[240:243]
  ds_read_u16_d16_hi v14, v4 offset:2464
  ds_read_u16_d16_hi v15, v4 offset:3632
  s_waitcnt lgkmcnt(15)
  v_mfma_f32_16x16x32_bf16 v[164:167], v[68:71], v[36:39], v[164:167]
  v_add_f32 v24, v151, v154
  v_add_f32 v25, v155, v158
  v_mfma_f32_16x16x32_bf16 v[180:183], v[76:79], v[36:39], v[180:183]
  v_add_f32 v24, v24, v157
  ds_bpermute_b32 v28, v7, v25
  v_mfma_f32_16x16x32_bf16 v[196:199], v[84:87], v[36:39], v[196:199]
  ds_bpermute_b32 v29, v7, v159
  ds_bpermute_b32 v27, v7, v24
  v_mfma_f32_16x16x32_bf16 v[212:215], v[92:95], v[36:39], v[212:215]
  v_add_f32 v21, v145, v148
  v_add_f32 v22, v146, v149
  v_mfma_f32_16x16x32_bf16 v[228:231], v[100:103], v[36:39], v[228:231]
  v_add_f32 v23, v147, v150
  v_add_f32 v22, v22, v152
  v_mfma_f32_16x16x32_bf16 v[244:247], v[108:111], v[36:39], v[244:247]
  v_add_f32 v23, v23, v153
  v_add_f32 v23, v23, v156
  s_waitcnt lgkmcnt(15)
  v_mfma_f32_16x16x32_bf16 v[168:171], v[68:71], v[40:43], v[168:171]
  v_mfma_f32_16x16x32_bf16 v[184:187], v[76:79], v[40:43], v[184:187]
  v_mfma_f32_16x16x32_bf16 v[200:203], v[84:87], v[40:43], v[200:203]
  v_mfma_f32_16x16x32_bf16 v[216:219], v[92:95], v[40:43], v[216:219]
  s_waitcnt lgkmcnt(0)
  v_cndmask_b32 v24, v27, v30, s[70:71]
  v_cndmask_b32 v25, v28, v31, s[70:71]
  v_mfma_f32_16x16x32_bf16 v[232:235], v[100:103], v[40:43], v[232:235]
  v_cndmask_b32 v26, v29, v11, s[70:71]
  v_add_f32 v20, v144, v24
  v_mfma_f32_16x16x32_bf16 v[248:251], v[108:111], v[40:43], v[248:251]
  v_add_f32 v21, v21, v25
  v_add_f32 v22, v22, v26
  v_mfma_f32_16x16x32_bf16 v[172:175], v[68:71], v[44:47], v[172:175]
  v_cvt_pk_bf16_f32 v24, v20, v21
  v_cvt_pk_bf16_f32 v25, v22, v23
  v_mfma_f32_16x16x32_bf16 v[188:191], v[76:79], v[44:47], v[188:191]
  v_lshlrev_b32 v20, 16, v24
  v_and_b32 v21, 0xffff0000, v24
  v_mfma_f32_16x16x32_bf16 v[204:207], v[84:87], v[44:47], v[204:207]
  v_lshlrev_b32 v22, 16, v25
  v_and_b32 v23, 0xffff0000, v25
  v_mfma_f32_16x16x32_bf16 v[220:223], v[92:95], v[44:47], v[220:223]
  v_fmac_f32 v20, v12, v10
  v_fmac_f32 v21, v13, v10
  v_mfma_f32_16x16x32_bf16 v[236:239], v[100:103], v[44:47], v[236:239]
  v_fmac_f32 v22, v14, v10
  v_fmac_f32 v23, v15, v10
  v_mfma_f32_16x16x32_bf16 v[252:255], v[108:111], v[44:47], v[252:255]
  v_cvt_pk_bf16_f32 v24, v20, v21
  v_cvt_pk_bf16_f32 v25, v22, v23
  ds_write_b16 v5, v24 offset:2304
  ds_write_b16_d16_hi v5, v24 offset:2448
  ds_write_b16 v5, v25 offset:2592
  ds_write_b16_d16_hi v5, v25 offset:2736
  v_mfma_f32_16x16x32_bf16 v[160:163], v[64:67], v[48:51], v[160:163]
  ds_read_b64 v[32:33], v3 offset:384
  ds_read_b64 v[34:35], v3 offset:392
  v_mfma_f32_16x16x32_bf16 v[176:179], v[72:75], v[48:51], v[176:179]
  ds_read_b64 v[36:37], v3 offset:1552
  ds_read_b64 v[38:39], v3 offset:1560
  v_mfma_f32_16x16x32_bf16 v[192:195], v[80:83], v[48:51], v[192:195]
  ds_read_b64 v[40:41], v3 offset:2720
  ds_read_b64 v[42:43], v3 offset:2728
  v_mfma_f32_16x16x32_bf16 v[208:211], v[88:91], v[48:51], v[208:211]
  ds_read_b64 v[44:45], v3 offset:3888
  ds_read_b64 v[46:47], v3 offset:3896
  v_mfma_f32_16x16x32_bf16 v[224:227], v[96:99], v[48:51], v[224:227]
  v_mfma_f32_16x16x32_bf16 v[240:243], v[104:107], v[48:51], v[240:243]
  v_mfma_f32_16x16x32_bf16 v[164:167], v[64:67], v[52:55], v[164:167]
  v_mfma_f32_16x16x32_bf16 v[180:183], v[72:75], v[52:55], v[180:183]
  v_mfma_f32_16x16x32_bf16 v[196:199], v[80:83], v[52:55], v[196:199]
  v_mfma_f32_16x16x32_bf16 v[212:215], v[88:91], v[52:55], v[212:215]
  v_mfma_f32_16x16x32_bf16 v[228:231], v[96:99], v[52:55], v[228:231]
  v_mfma_f32_16x16x32_bf16 v[244:247], v[104:107], v[52:55], v[244:247]
  v_mfma_f32_16x16x32_bf16 v[168:171], v[64:67], v[56:59], v[168:171]
  v_mfma_f32_16x16x32_bf16 v[184:187], v[72:75], v[56:59], v[184:187]
  v_mfma_f32_16x16x32_bf16 v[200:203], v[80:83], v[56:59], v[200:203]
  v_mfma_f32_16x16x32_bf16 v[216:219], v[88:91], v[56:59], v[216:219]
  v_mfma_f32_16x16x32_bf16 v[232:235], v[96:99], v[56:59], v[232:235]
  v_mfma_f32_16x16x32_bf16 v[248:251], v[104:107], v[56:59], v[248:251]
  v_mfma_f32_16x16x32_bf16 v[172:175], v[64:67], v[60:63], v[172:175]
  v_mfma_f32_16x16x32_bf16 v[188:191], v[72:75], v[60:63], v[188:191]
  v_mfma_f32_16x16x32_bf16 v[204:207], v[80:83], v[60:63], v[204:207]
  v_mfma_f32_16x16x32_bf16 v[220:223], v[88:91], v[60:63], v[220:223]
  v_mfma_f32_16x16x32_bf16 v[236:239], v[96:99], v[60:63], v[236:239]
  v_mfma_f32_16x16x32_bf16 v[252:255], v[104:107], v[60:63], v[252:255]
  s_waitcnt lgkmcnt(6)
  v_mfma_f32_16x16x32_bf16 v[176:179], v[68:71], v[32:35], v[176:179]
  ds_read_b64 v[48:49], v3 offset:448
  ds_read_b64 v[50:51], v3 offset:456
  v_mfma_f32_16x16x32_bf16 v[192:195], v[76:79], v[32:35], v[192:195]
  ds_read_b64 v[52:53], v3 offset:1616
  ds_read_b64 v[54:55], v3 offset:1624
  v_mfma_f32_16x16x32_bf16 v[208:211], v[84:87], v[32:35], v[208:211]
  ds_read_b64 v[56:57], v3 offset:2784
  ds_read_b64 v[58:59], v3 offset:2792
  v_mfma_f32_16x16x32_bf16 v[224:227], v[92:95], v[32:35], v[224:227]
  ds_read_b64 v[60:61], v3 offset:3952
  ds_read_b64 v[62:63], v3 offset:3960
  v_mfma_f32_16x16x32_bf16 v[240:243], v[100:103], v[32:35], v[240:243]
  ds_read_u16_d16_hi v12, v4 offset:256
  ds_read_u16_d16_hi v13, v4 offset:1424
  s_waitcnt lgkmcnt(14)
  v_mfma_f32_16x16x32_bf16 v[180:183], v[68:71], v[36:39], v[180:183]
  ds_read_u16_d16_hi v14, v4 offset:2592
  ds_read_u16_d16_hi v15, v4 offset:3760
  v_mfma_f32_16x16x32_bf16 v[196:199], v[76:79], v[36:39], v[196:199]
  v_add_f32 v24, v167, v170
  v_add_f32 v25, v171, v174
  v_mfma_f32_16x16x32_bf16 v[212:215], v[84:87], v[36:39], v[212:215]
  v_add_f32 v24, v24, v173
  ds_bpermute_b32 v31, v7, v25
  v_mfma_f32_16x16x32_bf16 v[228:231], v[92:95], v[36:39], v[228:231]
  ds_bpermute_b32 v11, v7, v175
  ds_bpermute_b32 v30, v7, v24
  v_mfma_f32_16x16x32_bf16 v[244:247], v[100:103], v[36:39], v[244:247]
  v_add_f32 v21, v161, v164
  v_add_f32 v22, v162, v165
  s_waitcnt lgkmcnt(15)
  v_mfma_f32_16x16x32_bf16 v[184:187], v[68:71], v[40:43], v[184:187]
  v_add_f32 v23, v163, v166
  v_add_f32 v22, v22, v168
  v_mfma_f32_16x16x32_bf16 v[200:203], v[76:79], v[40:43], v[200:203]
  v_add_f32 v23, v23, v169
  v_add_f32 v23, v23, v172
  v_mfma_f32_16x16x32_bf16 v[216:219], v[84:87], v[40:43], v[216:219]
  v_mfma_f32_16x16x32_bf16 v[232:235], v[92:95], v[40:43], v[232:235]
  v_mfma_f32_16x16x32_bf16 v[248:251], v[100:103], v[40:43], v[248:251]
  v_mfma_f32_16x16x32_bf16 v[188:191], v[68:71], v[44:47], v[188:191]
  s_waitcnt lgkmcnt(0)
  v_cndmask_b32 v24, v30, v27, s[70:71]
  v_cndmask_b32 v25, v31, v28, s[70:71]
  v_mfma_f32_16x16x32_bf16 v[204:207], v[76:79], v[44:47], v[204:207]
  v_cndmask_b32 v26, v11, v29, s[70:71]
  v_add_f32 v20, v160, v24
  v_mfma_f32_16x16x32_bf16 v[220:223], v[84:87], v[44:47], v[220:223]
  v_add_f32 v21, v21, v25
  v_add_f32 v22, v22, v26
  v_mfma_f32_16x16x32_bf16 v[236:239], v[92:95], v[44:47], v[236:239]
  v_cvt_pk_bf16_f32 v24, v20, v21
  v_cvt_pk_bf16_f32 v25, v22, v23
  v_mfma_f32_16x16x32_bf16 v[252:255], v[100:103], v[44:47], v[252:255]
  v_lshlrev_b32 v20, 16, v24
  v_and_b32 v21, 0xffff0000, v24
  v_lshlrev_b32 v22, 16, v25
  v_and_b32 v23, 0xffff0000, v25
  v_fmac_f32 v20, v12, v10
  v_fmac_f32 v21, v13, v10
  v_fmac_f32 v22, v14, v10
  v_fmac_f32 v23, v15, v10
  v_cvt_pk_bf16_f32 v24, v20, v21
  v_cvt_pk_bf16_f32 v25, v22, v23
  ds_write_b16 v5, v24 offset:4608
  ds_write_b16_d16_hi v5, v24 offset:4752
  ds_write_b16 v5, v25 offset:4896
  ds_write_b16_d16_hi v5, v25 offset:5040
  v_mfma_f32_16x16x32_bf16 v[176:179], v[64:67], v[48:51], v[176:179]
  ds_read_b64 v[32:33], v3 offset:512
  ds_read_b64 v[34:35], v3 offset:520
  v_mfma_f32_16x16x32_bf16 v[192:195], v[72:75], v[48:51], v[192:195]
  ds_read_b64 v[36:37], v3 offset:1680
  ds_read_b64 v[38:39], v3 offset:1688
  v_mfma_f32_16x16x32_bf16 v[208:211], v[80:83], v[48:51], v[208:211]
  ds_read_b64 v[40:41], v3 offset:2848
  ds_read_b64 v[42:43], v3 offset:2856
  v_mfma_f32_16x16x32_bf16 v[224:227], v[88:91], v[48:51], v[224:227]
  ds_read_b64 v[44:45], v3 offset:4016
  ds_read_b64 v[46:47], v3 offset:4024
  v_mfma_f32_16x16x32_bf16 v[240:243], v[96:99], v[48:51], v[240:243]
  v_mfma_f32_16x16x32_bf16 v[180:183], v[64:67], v[52:55], v[180:183]
  v_mfma_f32_16x16x32_bf16 v[196:199], v[72:75], v[52:55], v[196:199]
  v_mfma_f32_16x16x32_bf16 v[212:215], v[80:83], v[52:55], v[212:215]
  v_mfma_f32_16x16x32_bf16 v[228:231], v[88:91], v[52:55], v[228:231]
  v_mfma_f32_16x16x32_bf16 v[244:247], v[96:99], v[52:55], v[244:247]
  v_mfma_f32_16x16x32_bf16 v[184:187], v[64:67], v[56:59], v[184:187]
  v_mfma_f32_16x16x32_bf16 v[200:203], v[72:75], v[56:59], v[200:203]
  v_mfma_f32_16x16x32_bf16 v[216:219], v[80:83], v[56:59], v[216:219]
  v_mfma_f32_16x16x32_bf16 v[232:235], v[88:91], v[56:59], v[232:235]
  v_mfma_f32_16x16x32_bf16 v[248:251], v[96:99], v[56:59], v[248:251]
  v_mfma_f32_16x16x32_bf16 v[188:191], v[64:67], v[60:63], v[188:191]
  v_mfma_f32_16x16x32_bf16 v[204:207], v[72:75], v[60:63], v[204:207]
  v_mfma_f32_16x16x32_bf16 v[220:223], v[80:83], v[60:63], v[220:223]
  v_mfma_f32_16x16x32_bf16 v[236:239], v[88:91], v[60:63], v[236:239]
  v_mfma_f32_16x16x32_bf16 v[252:255], v[96:99], v[60:63], v[252:255]
  s_waitcnt lgkmcnt(6)
  v_mfma_f32_16x16x32_bf16 v[192:195], v[68:71], v[32:35], v[192:195]
  ds_read_b64 v[48:49], v3 offset:576
  ds_read_b64 v[50:51], v3 offset:584
  v_mfma_f32_16x16x32_bf16 v[208:211], v[76:79], v[32:35], v[208:211]
  ds_read_b64 v[52:53], v3 offset:1744
  ds_read_b64 v[54:55], v3 offset:1752
  v_mfma_f32_16x16x32_bf16 v[224:227], v[84:87], v[32:35], v[224:227]
  ds_read_b64 v[56:57], v3 offset:2912
  ds_read_b64 v[58:59], v3 offset:2920
  v_mfma_f32_16x16x32_bf16 v[240:243], v[92:95], v[32:35], v[240:243]
  ds_read_b64 v[60:61], v3 offset:4080
  ds_read_b64 v[62:63], v3 offset:4088
  s_waitcnt lgkmcnt(12)
  v_mfma_f32_16x16x32_bf16 v[196:199], v[68:71], v[36:39], v[196:199]
  ds_read_u16_d16_hi v12, v4 offset:384
  ds_read_u16_d16_hi v13, v4 offset:1552
  v_mfma_f32_16x16x32_bf16 v[212:215], v[76:79], v[36:39], v[212:215]
  ds_read_u16_d16_hi v14, v4 offset:2720
  ds_read_u16_d16_hi v15, v4 offset:3888
  v_mfma_f32_16x16x32_bf16 v[228:231], v[84:87], v[36:39], v[228:231]
  v_add_f32 v24, v183, v186
  v_add_f32 v25, v187, v190
  v_mfma_f32_16x16x32_bf16 v[244:247], v[92:95], v[36:39], v[244:247]
  v_add_f32 v24, v24, v189
  ds_bpermute_b32 v28, v7, v25
  s_waitcnt lgkmcnt(15)
  v_mfma_f32_16x16x32_bf16 v[200:203], v[68:71], v[40:43], v[200:203]
  ds_bpermute_b32 v29, v7, v191
  ds_bpermute_b32 v27, v7, v24
  v_mfma_f32_16x16x32_bf16 v[216:219], v[76:79], v[40:43], v[216:219]
  v_add_f32 v21, v177, v180
  v_add_f32 v22, v178, v181
  v_mfma_f32_16x16x32_bf16 v[232:235], v[84:87], v[40:43], v[232:235]
  v_add_f32 v23, v179, v182
  v_add_f32 v22, v22, v184
  v_mfma_f32_16x16x32_bf16 v[248:251], v[92:95], v[40:43], v[248:251]
  v_add_f32 v23, v23, v185
  v_add_f32 v23, v23, v188
  s_waitcnt lgkmcnt(15)
  v_mfma_f32_16x16x32_bf16 v[204:207], v[68:71], v[44:47], v[204:207]
  v_mfma_f32_16x16x32_bf16 v[220:223], v[76:79], v[44:47], v[220:223]
  v_mfma_f32_16x16x32_bf16 v[236:239], v[84:87], v[44:47], v[236:239]
  v_mfma_f32_16x16x32_bf16 v[252:255], v[92:95], v[44:47], v[252:255]
  s_waitcnt lgkmcnt(0)
  v_cndmask_b32 v24, v27, v30, s[70:71]
  v_cndmask_b32 v25, v28, v31, s[70:71]
  v_cndmask_b32 v26, v29, v11, s[70:71]
  v_add_f32 v20, v176, v24
  v_add_f32 v21, v21, v25
  v_add_f32 v22, v22, v26
  v_cvt_pk_bf16_f32 v24, v20, v21
  v_cvt_pk_bf16_f32 v25, v22, v23
  v_lshlrev_b32 v20, 16, v24
  v_and_b32 v21, 0xffff0000, v24
  v_lshlrev_b32 v22, 16, v25
  v_and_b32 v23, 0xffff0000, v25
  v_fmac_f32 v20, v12, v10
  v_fmac_f32 v21, v13, v10
  v_fmac_f32 v22, v14, v10
  v_fmac_f32 v23, v15, v10
  v_cvt_pk_bf16_f32 v24, v20, v21
  v_cvt_pk_bf16_f32 v25, v22, v23
  ds_write_b16 v5, v24 offset:6912
  ds_write_b16_d16_hi v5, v24 offset:7056
  ds_write_b16 v5, v25 offset:7200
  ds_write_b16_d16_hi v5, v25 offset:7344
  v_mfma_f32_16x16x32_bf16 v[192:195], v[64:67], v[48:51], v[192:195]
  ds_read_b64 v[32:33], v3 offset:640
  ds_read_b64 v[34:35], v3 offset:648
  v_mfma_f32_16x16x32_bf16 v[208:211], v[72:75], v[48:51], v[208:211]
  ds_read_b64 v[36:37], v3 offset:1808
  ds_read_b64 v[38:39], v3 offset:1816
  v_mfma_f32_16x16x32_bf16 v[224:227], v[80:83], v[48:51], v[224:227]
  ds_read_b64 v[40:41], v3 offset:2976
  ds_read_b64 v[42:43], v3 offset:2984
  v_mfma_f32_16x16x32_bf16 v[240:243], v[88:91], v[48:51], v[240:243]
  ds_read_b64 v[44:45], v3 offset:4144
  ds_read_b64 v[46:47], v3 offset:4152
  v_mfma_f32_16x16x32_bf16 v[196:199], v[64:67], v[52:55], v[196:199]
  ds_read_b64 v[96:97], v3 offset:704
  ds_read_b64 v[98:99], v3 offset:712
  v_mfma_f32_16x16x32_bf16 v[212:215], v[72:75], v[52:55], v[212:215]
  ds_read_b64 v[100:101], v3 offset:1872
  ds_read_b64 v[102:103], v3 offset:1880
  v_mfma_f32_16x16x32_bf16 v[228:231], v[80:83], v[52:55], v[228:231]
  ds_read_b64 v[104:105], v3 offset:3040
  ds_read_b64 v[106:107], v3 offset:3048
  v_mfma_f32_16x16x32_bf16 v[244:247], v[88:91], v[52:55], v[244:247]
  ds_read_b64 v[108:109], v3 offset:4208
  ds_read_b64 v[110:111], v3 offset:4216
  v_mfma_f32_16x16x32_bf16 v[200:203], v[64:67], v[56:59], v[200:203]
  ds_read_b64 v[128:129], v3 offset:768
  ds_read_b64 v[130:131], v3 offset:776
  v_mfma_f32_16x16x32_bf16 v[216:219], v[72:75], v[56:59], v[216:219]
  ds_read_b64 v[132:133], v3 offset:1936
  ds_read_b64 v[134:135], v3 offset:1944
  v_mfma_f32_16x16x32_bf16 v[232:235], v[80:83], v[56:59], v[232:235]
  ds_read_b64 v[136:137], v3 offset:3104
  ds_read_b64 v[138:139], v3 offset:3112
  v_mfma_f32_16x16x32_bf16 v[248:251], v[88:91], v[56:59], v[248:251]
  ds_read_b64 v[140:141], v3 offset:4272
  ds_read_b64 v[142:143], v3 offset:4280
  v_mfma_f32_16x16x32_bf16 v[204:207], v[64:67], v[60:63], v[204:207]
  ds_read_b64 v[144:145], v3 offset:832
  ds_read_b64 v[146:147], v3 offset:840
  v_mfma_f32_16x16x32_bf16 v[220:223], v[72:75], v[60:63], v[220:223]
  ds_read_b64 v[148:149], v3 offset:2000
  ds_read_b64 v[150:151], v3 offset:2008
  v_mfma_f32_16x16x32_bf16 v[236:239], v[80:83], v[60:63], v[236:239]
  ds_read_b64 v[152:153], v3 offset:3168
  ds_read_b64 v[154:155], v3 offset:3176
  v_mfma_f32_16x16x32_bf16 v[252:255], v[88:91], v[60:63], v[252:255]
  ds_read_b64 v[156:157], v3 offset:4336
  ds_read_b64 v[158:159], v3 offset:4344
  ds_read_b64 v[160:161], v3 offset:896
  ds_read_b64 v[162:163], v3 offset:904
  ds_read_b64 v[164:165], v3 offset:2064
  ds_read_b64 v[166:167], v3 offset:2072
  ds_read_b64 v[168:169], v3 offset:3232
  ds_read_b64 v[170:171], v3 offset:3240
  ds_read_b64 v[172:173], v3 offset:4400
  ds_read_b64 v[174:175], v3 offset:4408
  ds_read_b64 v[176:177], v3 offset:960
  ds_read_b64 v[178:179], v3 offset:968
  ds_read_b64 v[180:181], v3 offset:2128
  ds_read_b64 v[182:183], v3 offset:2136
  ds_read_b64 v[184:185], v3 offset:3296
  ds_read_b64 v[186:187], v3 offset:3304
  ds_read_b64 v[188:189], v3 offset:4464
  ds_read_b64 v[190:191], v3 offset:4472
  s_waitcnt lgkmcnt(15)
  v_mfma_f32_16x16x32_bf16 v[208:211], v[68:71], v[32:35], v[208:211]
  ds_read_u16_d16_hi v12, v4 offset:512
  ds_read_u16_d16_hi v13, v4 offset:1680
  v_mfma_f32_16x16x32_bf16 v[212:215], v[68:71], v[36:39], v[212:215]
  ds_read_u16_d16_hi v14, v4 offset:2848
  ds_read_u16_d16_hi v15, v4 offset:4016
  v_mfma_f32_16x16x32_bf16 v[216:219], v[68:71], v[40:43], v[216:219]
  v_add_f32 v24, v199, v202
  v_add_f32 v25, v203, v206
  v_mfma_f32_16x16x32_bf16 v[220:223], v[68:71], v[44:47], v[220:223]
  v_add_f32 v24, v24, v205
  ds_bpermute_b32 v31, v7, v25
  v_mfma_f32_16x16x32_bf16 v[208:211], v[64:67], v[96:99], v[208:211]
  ds_bpermute_b32 v11, v7, v207
  ds_bpermute_b32 v30, v7, v24
  v_mfma_f32_16x16x32_bf16 v[212:215], v[64:67], v[100:103], v[212:215]
  v_add_f32 v21, v193, v196
  v_add_f32 v22, v194, v197
  v_mfma_f32_16x16x32_bf16 v[216:219], v[64:67], v[104:107], v[216:219]
  v_add_f32 v23, v195, v198
  v_add_f32 v22, v22, v200
  v_mfma_f32_16x16x32_bf16 v[220:223], v[64:67], v[108:111], v[220:223]
  v_add_f32 v23, v23, v201
  v_add_f32 v23, v23, v204
  s_waitcnt lgkmcnt(0)
  v_cndmask_b32 v24, v30, v27, s[70:71]
  v_cndmask_b32 v25, v31, v28, s[70:71]
  v_cndmask_b32 v26, v11, v29, s[70:71]
  v_add_f32 v20, v192, v24
  v_add_f32 v21, v21, v25
  v_add_f32 v22, v22, v26
  v_cvt_pk_bf16_f32 v24, v20, v21
  v_cvt_pk_bf16_f32 v25, v22, v23
  v_lshlrev_b32 v20, 16, v24
  v_and_b32 v21, 0xffff0000, v24
  v_lshlrev_b32 v22, 16, v25
  v_and_b32 v23, 0xffff0000, v25
  v_fmac_f32 v20, v12, v10
  v_fmac_f32 v21, v13, v10
  v_fmac_f32 v22, v14, v10
  v_fmac_f32 v23, v15, v10
  v_cvt_pk_bf16_f32 v24, v20, v21
  v_cvt_pk_bf16_f32 v25, v22, v23
  ds_write_b16 v5, v24 offset:9216
  ds_write_b16_d16_hi v5, v24 offset:9360
  ds_write_b16 v5, v25 offset:9504
  ds_write_b16_d16_hi v5, v25 offset:9648
  v_mfma_f32_16x16x32_bf16 v[224:227], v[76:79], v[32:35], v[224:227]
  ds_read_u16_d16_hi v12, v4 offset:640
  ds_read_u16_d16_hi v13, v4 offset:1808
  v_mfma_f32_16x16x32_bf16 v[228:231], v[76:79], v[36:39], v[228:231]
  ds_read_u16_d16_hi v14, v4 offset:2976
  ds_read_u16_d16_hi v15, v4 offset:4144
  v_mfma_f32_16x16x32_bf16 v[232:235], v[76:79], v[40:43], v[232:235]
  v_add_f32 v24, v215, v218
  v_add_f32 v25, v219, v222
  v_mfma_f32_16x16x32_bf16 v[236:239], v[76:79], v[44:47], v[236:239]
  v_add_f32 v24, v24, v221
  ds_bpermute_b32 v28, v7, v25
  v_mfma_f32_16x16x32_bf16 v[224:227], v[72:75], v[96:99], v[224:227]
  ds_bpermute_b32 v29, v7, v223
  ds_bpermute_b32 v27, v7, v24
  v_mfma_f32_16x16x32_bf16 v[228:231], v[72:75], v[100:103], v[228:231]
  v_add_f32 v21, v209, v212
  v_add_f32 v22, v210, v213
  v_mfma_f32_16x16x32_bf16 v[232:235], v[72:75], v[104:107], v[232:235]
  v_add_f32 v23, v211, v214
  v_add_f32 v22, v22, v216
  v_mfma_f32_16x16x32_bf16 v[236:239], v[72:75], v[108:111], v[236:239]
  v_add_f32 v23, v23, v217
  v_add_f32 v23, v23, v220
  v_mfma_f32_16x16x32_bf16 v[224:227], v[68:71], v[128:131], v[224:227]
  v_mfma_f32_16x16x32_bf16 v[228:231], v[68:71], v[132:135], v[228:231]
  v_mfma_f32_16x16x32_bf16 v[232:235], v[68:71], v[136:139], v[232:235]
  v_mfma_f32_16x16x32_bf16 v[236:239], v[68:71], v[140:143], v[236:239]
  s_waitcnt lgkmcnt(0)
  v_cndmask_b32 v24, v27, v30, s[70:71]
  v_cndmask_b32 v25, v28, v31, s[70:71]
  v_mfma_f32_16x16x32_bf16 v[224:227], v[64:67], v[144:147], v[224:227]
  v_cndmask_b32 v26, v29, v11, s[70:71]
  v_add_f32 v20, v208, v24
  v_mfma_f32_16x16x32_bf16 v[228:231], v[64:67], v[148:151], v[228:231]
  v_add_f32 v21, v21, v25
  v_add_f32 v22, v22, v26
  v_mfma_f32_16x16x32_bf16 v[232:235], v[64:67], v[152:155], v[232:235]
  v_cvt_pk_bf16_f32 v24, v20, v21
  v_cvt_pk_bf16_f32 v25, v22, v23
  v_mfma_f32_16x16x32_bf16 v[236:239], v[64:67], v[156:159], v[236:239]
  v_lshlrev_b32 v20, 16, v24
  v_and_b32 v21, 0xffff0000, v24
  v_lshlrev_b32 v22, 16, v25
  v_and_b32 v23, 0xffff0000, v25
  v_fmac_f32 v20, v12, v10
  v_fmac_f32 v21, v13, v10
  v_fmac_f32 v22, v14, v10
  v_fmac_f32 v23, v15, v10
  v_cvt_pk_bf16_f32 v24, v20, v21
  v_cvt_pk_bf16_f32 v25, v22, v23
  ds_write_b16 v5, v24 offset:11520
  ds_write_b16_d16_hi v5, v24 offset:11664
  ds_write_b16 v5, v25 offset:11808
  ds_write_b16_d16_hi v5, v25 offset:11952
  v_mfma_f32_16x16x32_bf16 v[240:243], v[84:87], v[32:35], v[240:243]
  ds_read_u16_d16_hi v12, v4 offset:768
  ds_read_u16_d16_hi v13, v4 offset:1936
  v_mfma_f32_16x16x32_bf16 v[244:247], v[84:87], v[36:39], v[244:247]
  ds_read_u16_d16_hi v14, v4 offset:3104
  ds_read_u16_d16_hi v15, v4 offset:4272
  v_mfma_f32_16x16x32_bf16 v[248:251], v[84:87], v[40:43], v[248:251]
  v_add_f32 v24, v231, v234
  v_add_f32 v25, v235, v238
  v_mfma_f32_16x16x32_bf16 v[252:255], v[84:87], v[44:47], v[252:255]
  v_add_f32 v24, v24, v237
  ds_bpermute_b32 v31, v7, v25
  v_mfma_f32_16x16x32_bf16 v[240:243], v[80:83], v[96:99], v[240:243]
  ds_bpermute_b32 v11, v7, v239
  ds_bpermute_b32 v30, v7, v24
  v_mfma_f32_16x16x32_bf16 v[244:247], v[80:83], v[100:103], v[244:247]
  v_add_f32 v21, v225, v228
  v_add_f32 v22, v226, v229
  v_mfma_f32_16x16x32_bf16 v[248:251], v[80:83], v[104:107], v[248:251]
  v_add_f32 v23, v227, v230
  v_add_f32 v22, v22, v232
  v_mfma_f32_16x16x32_bf16 v[252:255], v[80:83], v[108:111], v[252:255]
  v_add_f32 v23, v23, v233
  v_add_f32 v23, v23, v236
  v_mfma_f32_16x16x32_bf16 v[240:243], v[76:79], v[128:131], v[240:243]
  v_mfma_f32_16x16x32_bf16 v[244:247], v[76:79], v[132:135], v[244:247]
  v_mfma_f32_16x16x32_bf16 v[248:251], v[76:79], v[136:139], v[248:251]
  v_mfma_f32_16x16x32_bf16 v[252:255], v[76:79], v[140:143], v[252:255]
  v_mfma_f32_16x16x32_bf16 v[240:243], v[72:75], v[144:147], v[240:243]
  v_mfma_f32_16x16x32_bf16 v[244:247], v[72:75], v[148:151], v[244:247]
  s_waitcnt lgkmcnt(0)
  v_cndmask_b32 v24, v30, v27, s[70:71]
  v_cndmask_b32 v25, v31, v28, s[70:71]
  v_mfma_f32_16x16x32_bf16 v[248:251], v[72:75], v[152:155], v[248:251]
  v_cndmask_b32 v26, v11, v29, s[70:71]
  v_add_f32 v20, v224, v24
  v_mfma_f32_16x16x32_bf16 v[252:255], v[72:75], v[156:159], v[252:255]
  v_add_f32 v21, v21, v25
  v_add_f32 v22, v22, v26
  v_mfma_f32_16x16x32_bf16 v[240:243], v[68:71], v[160:163], v[240:243]
  v_cvt_pk_bf16_f32 v24, v20, v21
  v_cvt_pk_bf16_f32 v25, v22, v23
  v_mfma_f32_16x16x32_bf16 v[244:247], v[68:71], v[164:167], v[244:247]
  v_lshlrev_b32 v20, 16, v24
  v_and_b32 v21, 0xffff0000, v24
  v_mfma_f32_16x16x32_bf16 v[248:251], v[68:71], v[168:171], v[248:251]
  v_lshlrev_b32 v22, 16, v25
  v_and_b32 v23, 0xffff0000, v25
  v_mfma_f32_16x16x32_bf16 v[252:255], v[68:71], v[172:175], v[252:255]
  v_fmac_f32 v20, v12, v10
  v_fmac_f32 v21, v13, v10
  v_mfma_f32_16x16x32_bf16 v[240:243], v[64:67], v[176:179], v[240:243]
  v_fmac_f32 v22, v14, v10
  v_fmac_f32 v23, v15, v10
  v_mfma_f32_16x16x32_bf16 v[244:247], v[64:67], v[180:183], v[244:247]
  v_cvt_pk_bf16_f32 v24, v20, v21
  v_cvt_pk_bf16_f32 v25, v22, v23
  v_mfma_f32_16x16x32_bf16 v[248:251], v[64:67], v[184:187], v[248:251]
  ds_write_b16 v5, v24 offset:13824
  ds_write_b16_d16_hi v5, v24 offset:13968
  v_mfma_f32_16x16x32_bf16 v[252:255], v[64:67], v[188:191], v[252:255]
  ds_write_b16 v5, v25 offset:14112
  ds_write_b16_d16_hi v5, v25 offset:14256
  ds_read_u16_d16_hi v12, v4 offset:896
  ds_read_u16_d16_hi v13, v4 offset:2064
  ds_read_u16_d16_hi v14, v4 offset:3232
  ds_read_u16_d16_hi v15, v4 offset:4400
  v_add_f32 v24, v247, v250
  s_nop 0
  v_add_f32 v25, v251, v254
  v_add_f32 v24, v24, v253
  ds_bpermute_b32 v28, v7, v25
  ds_bpermute_b32 v29, v7, v255
  ds_bpermute_b32 v27, v7, v24
  v_add_f32 v21, v241, v244
  v_add_f32 v22, v242, v245
  v_add_f32 v23, v243, v246
  v_add_f32 v22, v22, v248
  v_add_f32 v23, v23, v249
  v_add_f32 v23, v23, v252
  s_waitcnt lgkmcnt(0)
  v_cndmask_b32 v24, v27, v30, s[70:71]
  v_cndmask_b32 v25, v28, v31, s[70:71]
  v_cndmask_b32 v26, v29, v11, s[70:71]
  v_add_f32 v20, v240, v24
  v_add_f32 v21, v21, v25
  v_add_f32 v22, v22, v26
  v_cvt_pk_bf16_f32 v24, v20, v21
  v_cvt_pk_bf16_f32 v25, v22, v23
  v_lshlrev_b32 v20, 16, v24
  v_and_b32 v21, 0xffff0000, v24
  v_lshlrev_b32 v22, 16, v25
  v_and_b32 v23, 0xffff0000, v25
  v_fmac_f32 v20, v12, v10
  v_fmac_f32 v21, v13, v10
  v_fmac_f32 v22, v14, v10
  v_fmac_f32 v23, v15, v10
  v_cvt_pk_bf16_f32 v24, v20, v21
  v_cvt_pk_bf16_f32 v25, v22, v23
  ds_write_b16 v5, v24 offset:16128
  ds_write_b16_d16_hi v5, v24 offset:16272
  ds_write_b16 v5, v25 offset:16416
  ds_write_b16_d16_hi v5, v25 offset:16560
  s_setprio 0
  s_lshl_b32 s7, s63, 6
  v_add_u32 v22, s7, v2
  v_lshlrev_b32 v16, 3, v22
  v_add_u32 v16, 131072, v16
  v_add_u32 v17, 4096, v16
  v_add_u32 v18, 8192, v16
  v_add_u32 v19, 12288, v16
  s_lshl_b32 s7, s60, 1
  v_mov_b32 v6, s7
  global_load_dwordx2 v[4:5], v6, s[40:41]
  global_load_dwordx2 v[128:129], v16, s[48:49] offset:0 sc1
  global_load_dwordx2 v[130:131], v16, s[48:49] offset:2048 sc1
  global_load_dwordx2 v[132:133], v17, s[48:49] offset:0 sc1
  global_load_dwordx2 v[134:135], v17, s[48:49] offset:2048 sc1
  global_load_dwordx2 v[136:137], v18, s[48:49] offset:0 sc1
  global_load_dwordx2 v[138:139], v18, s[48:49] offset:2048 sc1
  global_load_dwordx2 v[140:141], v19, s[48:49] offset:0 sc1
  global_load_dwordx2 v[142:143], v19, s[48:49] offset:2048 sc1
  v_and_b32 v20, 15, v22
  v_mul_u32_u24 v9, 144, v20
  v_lshrrev_b32 v23, 4, v22
  v_lshl_add_u32 v9, v23, 3, v9
  v_add_u32 v7, 92416, v9
  v_add_u32 v9, 33024, v9
  s_lshl_b32 s7, s60, 1
  v_lshlrev_b32 v8, 11, v22
  v_add_u32 v8, s7, v8
  v_and_b32 v20, 3, v22
  v_mul_u32_u24 v3, 1168, v20
  v_lshrrev_b32 v20, 2, v22
  v_lshl_add_u32 v3, v20, 1, v3
  v_add_u32 v6, 57728, v3
  v_add_u32 v3, 131136, v3
  s_waitcnt lgkmcnt(0)
  s_lshl_b32 s7, s6, 2
  s_add_u32 s7, s7, 149696
  v_mov_b32 v20, s7
  v_mov_b32 v21, 2
  ds_write_b32 v20, v21
  v_mov_b32 v64, 0
  v_mov_b32 v65, 0
  v_mov_b32 v66, 0
  v_mov_b32 v67, 0
  v_mov_b32 v68, 0
  v_mov_b32 v69, 0
  v_mov_b32 v70, 0
  v_mov_b32 v71, 0
  v_mov_b32 v72, 0
  v_mov_b32 v73, 0
  v_mov_b32 v74, 0
  v_mov_b32 v75, 0
  v_mov_b32 v76, 0
  v_mov_b32 v77, 0
  v_mov_b32 v78, 0
  v_mov_b32 v79, 0
  v_mov_b32 v80, 0
  v_mov_b32 v81, 0
  v_mov_b32 v82, 0
  v_mov_b32 v83, 0
  v_mov_b32 v84, 0
  v_mov_b32 v85, 0
  v_mov_b32 v86, 0
  v_mov_b32 v87, 0
  v_mov_b32 v88, 0
  v_mov_b32 v89, 0
  v_mov_b32 v90, 0
  v_mov_b32 v91, 0
  v_mov_b32 v92, 0
  v_mov_b32 v93, 0
  v_mov_b32 v94, 0
  v_mov_b32 v95, 0
  v_mov_b32 v96, 0
  v_mov_b32 v97, 0
  v_mov_b32 v98, 0
  v_mov_b32 v99, 0
  v_mov_b32 v100, 0
  v_mov_b32 v101, 0
  v_mov_b32 v102, 0
  v_mov_b32 v103, 0
  v_mov_b32 v104, 0
  v_mov_b32 v105, 0
  v_mov_b32 v106, 0
  v_mov_b32 v107, 0
  v_mov_b32 v108, 0
  v_mov_b32 v109, 0
  v_mov_b32 v110, 0
  v_mov_b32 v111, 0
  v_mov_b32 v112, 0
  v_mov_b32 v113, 0
  v_mov_b32 v114, 0
  v_mov_b32 v115, 0
  v_mov_b32 v116, 0
  v_mov_b32 v117, 0
  v_mov_b32 v118, 0
  v_mov_b32 v119, 0
  v_mov_b32 v120, 0
  v_mov_b32 v121, 0
  v_mov_b32 v122, 0
  v_mov_b32 v123, 0
  v_mov_b32 v124, 0
  v_mov_b32 v125, 0
  v_mov_b32 v126, 0
  v_mov_b32 v127, 0
  s_mov_b32 s72, s44
  s_mov_b32 s73, s45
  v_mov_b32 v24, 149696
  s_mov_b32 s13, 0
L_lw_a2:
  ds_read_b128 v[20:23], v24
  s_waitcnt lgkmcnt(0)
  v_min_u32 v20, v20, v21
  v_min_u32 v22, v22, v23
  v_min_u32 v20, v20, v22
  s_nop 0
  v_readfirstlane_b32 s7, v20
  s_add_u32 s13, s13, 1
  s_cmp_ge_u32 s7, 2
  s_cbranch_scc1 L_lwd_a2
  s_cmp_lt_u32 s13, 0x400000
  s_cbranch_scc1 L_lw_a2
L_lwd_a2:
  ds_read_u16_d16_hi v64, v3 offset:0
  ds_read_u16_d16_hi v65, v3 offset:4672
  ds_read_u16_d16_hi v66, v3 offset:9344
  ds_read_u16_d16_hi v67, v3 offset:14016
  ds_read_b64 v[144:145], v7 offset:0
  ds_read_u16_d16_hi v68, v3 offset:128
  ds_read_u16_d16_hi v69, v3 offset:4800
  ds_read_u16_d16_hi v70, v3 offset:9472
  ds_read_u16_d16_hi v71, v3 offset:14144
  ds_read_b64 v[146:147], v7 offset:2304
  ds_read_u16_d16_hi v72, v3 offset:256
  ds_read_u16_d16_hi v73, v3 offset:4928
  ds_read_u16_d16_hi v74, v3 offset:9600
  ds_read_u16_d16_hi v75, v3 offset:14272
  ds_read_b64 v[148:149], v7 offset:4608
  ds_read_u16_d16_hi v76, v3 offset:384
  ds_read_u16_d16_hi v77, v3 offset:5056
  ds_read_u16_d16_hi v78, v3 offset:9728
  ds_read_u16_d16_hi v79, v3 offset:14400
  ds_read_b64 v[150:151], v7 offset:6912
  ds_read_u16_d16_hi v80, v3 offset:512
  ds_read_u16_d16_hi v81, v3 offset:5184
  ds_read_u16_d16_hi v82, v3 offset:9856
  ds_read_u16_d16_hi v83, v3 offset:14528
  ds_read_b64 v[152:153], v7 offset:9216
  ds_read_u16_d16_hi v84, v3 offset:640
  ds_read_u16_d16_hi v85, v3 offset:5312
  ds_read_u16_d16_hi v86, v3 offset:9984
  ds_read_u16_d16_hi v87, v3 offset:14656
  ds_read_b64 v[154:155], v7 offset:11520
  ds_read_u16_d16_hi v88, v3 offset:768
  ds_read_u16_d16_hi v89, v3 offset:5440
  ds_read_u16_d16_hi v90, v3 offset:10112
  ds_read_u16_d16_hi v91, v3 offset:14784
  ds_read_b64 v[156:157], v7 offset:13824
  ds_read_u16_d16_hi v92, v3 offset:896
  ds_read_u16_d16_hi v93, v3 offset:5568
  ds_read_u16_d16_hi v94, v3 offset:10240
  ds_read_u16_d16_hi v95, v3 offset:14912
  ds_read_b64 v[158:159], v7 offset:16128
  s_waitcnt vmcnt(0)
  v_lshlrev_b32 v60, 16, v4
  v_and_b32 v61, 0xffff0000, v4
  v_lshlrev_b32 v62, 16, v5
  v_and_b32 v63, 0xffff0000, v5
  v_mov_b32 v24, 149712
  s_mov_b32 s13, 0
L_lw_kvl:
  ds_read_b128 v[20:23], v24
  s_waitcnt lgkmcnt(0)
  v_min_u32 v20, v20, v21
  v_min_u32 v22, v22, v23
  v_min_u32 v20, v20, v22
  s_nop 0
  v_readfirstlane_b32 s7, v20
  s_add_u32 s13, s13, 1
  s_cmp_ge_u32 s7, 2
  s_cbranch_scc1 L_lwd_kvl
  s_cmp_lt_u32 s13, 0x400000
  s_cbranch_scc1 L_lw_kvl
L_lwd_kvl:
  ds_read_u16_d16_hi v96, v6 offset:0
  ds_read_u16_d16_hi v97, v6 offset:4672
  ds_read_u16_d16_hi v98, v6 offset:9344
  ds_read_u16_d16_hi v99, v6 offset:14016
  ds_read_u16_d16_hi v100, v6 offset:128
  ds_read_u16_d16_hi v101, v6 offset:4800
  ds_read_u16_d16_hi v102, v6 offset:9472
  ds_read_u16_d16_hi v103, v6 offset:14144
  ds_read_u16_d16_hi v104, v6 offset:256
  ds_read_u16_d16_hi v105, v6 offset:4928
  ds_read_u16_d16_hi v106, v6 offset:9600
  ds_read_u16_d16_hi v107, v6 offset:14272
  ds_read_u16_d16_hi v108, v6 offset:384
  ds_read_u16_d16_hi v109, v6 offset:5056
  ds_read_u16_d16_hi v110, v6 offset:9728
  ds_read_u16_d16_hi v111, v6 offset:14400
  ds_read_u16_d16_hi v112, v6 offset:512
  ds_read_u16_d16_hi v113, v6 offset:5184
  ds_read_u16_d16_hi v114, v6 offset:9856
  ds_read_u16_d16_hi v115, v6 offset:14528
  ds_read_u16_d16_hi v116, v6 offset:640
  ds_read_u16_d16_hi v117, v6 offset:5312
  ds_read_u16_d16_hi v118, v6 offset:9984
  ds_read_u16_d16_hi v119, v6 offset:14656
  ds_read_u16_d16_hi v120, v6 offset:768
  ds_read_u16_d16_hi v121, v6 offset:5440
  ds_read_u16_d16_hi v122, v6 offset:10112
  ds_read_u16_d16_hi v123, v6 offset:14784
  ds_read_u16_d16_hi v124, v6 offset:896
  ds_read_u16_d16_hi v125, v6 offset:5568
  ds_read_u16_d16_hi v126, v6 offset:10240
  ds_read_u16_d16_hi v127, v6 offset:14912
  s_mov_b32 s13, 0
L_gc0:
  v_cmp_ne_u32 vcc, s74, v129
  s_cbranch_vccz L_gok0
  s_add_u32 s13, s13, 1
  s_cmp_lt_u32 s13, 0x10000
  s_cbranch_scc0 L_gok0
  s_sleep 8
  global_load_dwordx2 v[128:129], v16, s[48:49] offset:0 sc1
  s_waitcnt vmcnt(0)
  s_branch L_gc0
L_gok0:
  v_lshlrev_b32 v40, 16, v144
  v_and_b32 v41, 0xffff0000, v144
  v_lshlrev_b32 v42, 16, v145
  v_and_b32 v43, 0xffff0000, v145
  v_mov_b32 v24, 149712
  s_mov_b32 s13, 0
L_lw_t0:
  ds_read_b128 v[20:23], v24
  s_waitcnt lgkmcnt(0)
  v_min_u32 v20, v20, v21
  v_min_u32 v22, v22, v23
  v_min_u32 v20, v20, v22
  s_nop 0
  v_readfirstlane_b32 s7, v20
  s_add_u32 s13, s13, 1
  s_cmp_ge_u32 s7, 3
  s_cbranch_scc1 L_lwd_t0
  s_cmp_lt_u32 s13, 0x400000
  s_cbranch_scc1 L_lw_t0
L_lwd_t0:
  ds_read_b64 v[34:35], v9 offset:0
  s_waitcnt lgkmcnt(0)
  v_lshlrev_b32 v44, 16, v34
  v_and_b32 v45, 0xffff0000, v34
  v_lshlrev_b32 v46, 16, v35
  v_and_b32 v47, 0xffff0000, v35
  v_fmac_f32 v44, v96, v60
  v_fmac_f32 v45, v97, v61
  v_fmac_f32 v46, v98, v62
  v_fmac_f32 v47, v99, v63
  v_mul_f32 v44, v44, v64
  v_mul_f32 v45, v45, v65
  v_mul_f32 v46, v46, v66
  v_mul_f32 v47, v47, v67
  v_cvt_pk_bf16_f32 v36, v44, v45
  v_cvt_pk_bf16_f32 v37, v46, v47
  v_lshlrev_b32 v44, 16, v36
  v_and_b32 v45, 0xffff0000, v36
  v_lshlrev_b32 v46, 16, v37
  v_and_b32 v47, 0xffff0000, v37
  v_sub_f32 v40, v40, v44
  v_sub_f32 v41, v41, v45
  v_sub_f32 v42, v42, v46
  v_sub_f32 v43, v43, v47
  v_fmac_f32 v44, v40, v128
  v_fmac_f32 v45, v41, v128
  v_fmac_f32 v46, v42, v128
  v_fmac_f32 v47, v43, v128
  v_cvt_pk_bf16_f32 v48, v44, v45
  v_cvt_pk_bf16_f32 v49, v46, v47
  global_store_dwordx2 v8, v[48:49], s[72:73]
  s_add_u32 s72, s72, 0x80000
  s_addc_u32 s73, s73, 0
  s_mov_b32 s13, 0
L_gc1:
  v_cmp_ne_u32 vcc, s74, v131
  s_cbranch_vccz L_gok1
  s_add_u32 s13, s13, 1
  s_cmp_lt_u32 s13, 0x10000
  s_cbranch_scc0 L_gok1
  s_sleep 8
  global_load_dwordx2 v[130:131], v16, s[48:49] offset:2048 sc1
  s_waitcnt vmcnt(0)
  s_branch L_gc1
L_gok1:
  v_lshlrev_b32 v40, 16, v146
  v_and_b32 v41, 0xffff0000, v146
  v_lshlrev_b32 v42, 16, v147
  v_and_b32 v43, 0xffff0000, v147
  v_mov_b32 v24, 149712
  s_mov_b32 s13, 0
L_lw_t1:
  ds_read_b128 v[20:23], v24
  s_waitcnt lgkmcnt(0)
  v_min_u32 v20, v20, v21
  v_min_u32 v22, v22, v23
  v_min_u32 v20, v20, v22
  s_nop 0
  v_readfirstlane_b32 s7, v20
  s_add_u32 s13, s13, 1
  s_cmp_ge_u32 s7, 4
  s_cbranch_scc1 L_lwd_t1
  s_cmp_lt_u32 s13, 0x400000
  s_cbranch_scc1 L_lw_t1
L_lwd_t1:
  ds_read_b64 v[34:35], v9 offset:2304
  s_waitcnt lgkmcnt(0)
  v_lshlrev_b32 v44, 16, v34
  v_and_b32 v45, 0xffff0000, v34
  v_lshlrev_b32 v46, 16, v35
  v_and_b32 v47, 0xffff0000, v35
  v_fmac_f32 v44, v100, v60
  v_fmac_f32 v45, v101, v61
  v_fmac_f32 v46, v102, v62
  v_fmac_f32 v47, v103, v63
  v_mul_f32 v44, v44, v68
  v_mul_f32 v45, v45, v69
  v_mul_f32 v46, v46, v70
  v_mul_f32 v47, v47, v71
  v_cvt_pk_bf16_f32 v36, v44, v45
  v_cvt_pk_bf16_f32 v37, v46, v47
  v_lshlrev_b32 v44, 16, v36
  v_and_b32 v45, 0xffff0000, v36
  v_lshlrev_b32 v46, 16, v37
  v_and_b32 v47, 0xffff0000, v37
  v_sub_f32 v40, v40, v44
  v_sub_f32 v41, v41, v45
  v_sub_f32 v42, v42, v46
  v_sub_f32 v43, v43, v47
  v_fmac_f32 v44, v40, v130
  v_fmac_f32 v45, v41, v130
  v_fmac_f32 v46, v42, v130
  v_fmac_f32 v47, v43, v130
  v_cvt_pk_bf16_f32 v50, v44, v45
  v_cvt_pk_bf16_f32 v51, v46, v47
  global_store_dwordx2 v8, v[50:51], s[72:73]
  s_add_u32 s72, s72, 0x80000
  s_addc_u32 s73, s73, 0
  s_mov_b32 s13, 0
L_gc2:
  v_cmp_ne_u32 vcc, s74, v133
  s_cbranch_vccz L_gok2
  s_add_u32 s13, s13, 1
  s_cmp_lt_u32 s13, 0x10000
  s_cbranch_scc0 L_gok2
  s_sleep 8
  global_load_dwordx2 v[132:133], v17, s[48:49] offset:0 sc1
  s_waitcnt vmcnt(0)
  s_branch L_gc2
L_gok2:
  v_lshlrev_b32 v40, 16, v148
  v_and_b32 v41, 0xffff0000, v148
  v_lshlrev_b32 v42, 16, v149
  v_and_b32 v43, 0xffff0000, v149
  v_mov_b32 v24, 149712
  s_mov_b32 s13, 0
L_lw_t2:
  ds_read_b128 v[20:23], v24
  s_waitcnt lgkmcnt(0)
  v_min_u32 v20, v20, v21
  v_min_u32 v22, v22, v23
  v_min_u32 v20, v20, v22
  s_nop 0
  v_readfirstlane_b32 s7, v20
  s_add_u32 s13, s13, 1
  s_cmp_ge_u32 s7, 5
  s_cbranch_scc1 L_lwd_t2
  s_cmp_lt_u32 s13, 0x400000
  s_cbranch_scc1 L_lw_t2
L_lwd_t2:
  ds_read_b64 v[34:35], v9 offset:4608
  s_waitcnt lgkmcnt(0)
  v_lshlrev_b32 v44, 16, v34
  v_and_b32 v45, 0xffff0000, v34
  v_lshlrev_b32 v46, 16, v35
  v_and_b32 v47, 0xffff0000, v35
  v_fmac_f32 v44, v104, v60
  v_fmac_f32 v45, v105, v61
  v_fmac_f32 v46, v106, v62
  v_fmac_f32 v47, v107, v63
  v_mul_f32 v44, v44, v72
  v_mul_f32 v45, v45, v73
  v_mul_f32 v46, v46, v74
  v_mul_f32 v47, v47, v75
  v_cvt_pk_bf16_f32 v36, v44, v45
  v_cvt_pk_bf16_f32 v37, v46, v47
  v_lshlrev_b32 v44, 16, v36
  v_and_b32 v45, 0xffff0000, v36
  v_lshlrev_b32 v46, 16, v37
  v_and_b32 v47, 0xffff0000, v37
  v_sub_f32 v40, v40, v44
  v_sub_f32 v41, v41, v45
  v_sub_f32 v42, v42, v46
  v_sub_f32 v43, v43, v47
  v_fmac_f32 v44, v40, v132
  v_fmac_f32 v45, v41, v132
  v_fmac_f32 v46, v42, v132
  v_fmac_f32 v47, v43, v132
  v_cvt_pk_bf16_f32 v48, v44, v45
  v_cvt_pk_bf16_f32 v49, v46, v47
  global_store_dwordx2 v8, v[48:49], s[72:73]
  s_add_u32 s72, s72, 0x80000
  s_addc_u32 s73, s73, 0
  s_mov_b32 s13, 0
L_gc3:
  v_cmp_ne_u32 vcc, s74, v135
  s_cbranch_vccz L_gok3
  s_add_u32 s13, s13, 1
  s_cmp_lt_u32 s13, 0x10000
  s_cbranch_scc0 L_gok3
  s_sleep 8
  global_load_dwordx2 v[134:135], v17, s[48:49] offset:2048 sc1
  s_waitcnt vmcnt(0)
  s_branch L_gc3
L_gok3:
  v_lshlrev_b32 v40, 16, v150
  v_and_b32 v41, 0xffff0000, v150
  v_lshlrev_b32 v42, 16, v151
  v_and_b32 v43, 0xffff0000, v151
  v_mov_b32 v24, 149712
  s_mov_b32 s13, 0
L_lw_t3:
  ds_read_b128 v[20:23], v24
  s_waitcnt lgkmcnt(0)
  v_min_u32 v20, v20, v21
  v_min_u32 v22, v22, v23
  v_min_u32 v20, v20, v22
  s_nop 0
  v_readfirstlane_b32 s7, v20
  s_add_u32 s13, s13, 1
  s_cmp_ge_u32 s7, 6
  s_cbranch_scc1 L_lwd_t3
  s_cmp_lt_u32 s13, 0x400000
  s_cbranch_scc1 L_lw_t3
L_lwd_t3:
  ds_read_b64 v[34:35], v9 offset:6912
  s_waitcnt lgkmcnt(0)
  v_lshlrev_b32 v44, 16, v34
  v_and_b32 v45, 0xffff0000, v34
  v_lshlrev_b32 v46, 16, v35
  v_and_b32 v47, 0xffff0000, v35
  v_fmac_f32 v44, v108, v60
  v_fmac_f32 v45, v109, v61
  v_fmac_f32 v46, v110, v62
  v_fmac_f32 v47, v111, v63
  v_mul_f32 v44, v44, v76
  v_mul_f32 v45, v45, v77
  v_mul_f32 v46, v46, v78
  v_mul_f32 v47, v47, v79
  v_cvt_pk_bf16_f32 v36, v44, v45
  v_cvt_pk_bf16_f32 v37, v46, v47
  v_lshlrev_b32 v44, 16, v36
  v_and_b32 v45, 0xffff0000, v36
  v_lshlrev_b32 v46, 16, v37
  v_and_b32 v47, 0xffff0000, v37
  v_sub_f32 v40, v40, v44
  v_sub_f32 v41, v41, v45
  v_sub_f32 v42, v42, v46
  v_sub_f32 v43, v43, v47
  v_fmac_f32 v44, v40, v134
  v_fmac_f32 v45, v41, v134
  v_fmac_f32 v46, v42, v134
  v_fmac_f32 v47, v43, v134
  v_cvt_pk_bf16_f32 v50, v44, v45
  v_cvt_pk_bf16_f32 v51, v46, v47
  global_store_dwordx2 v8, v[50:51], s[72:73]
  s_add_u32 s72, s72, 0x80000
  s_addc_u32 s73, s73, 0
  s_mov_b32 s13, 0
L_gc4:
  v_cmp_ne_u32 vcc, s74, v137
  s_cbranch_vccz L_gok4
  s_add_u32 s13, s13, 1
  s_cmp_lt_u32 s13, 0x10000
  s_cbranch_scc0 L_gok4
  s_sleep 8
  global_load_dwordx2 v[136:137], v18, s[48:49] offset:0 sc1
  s_waitcnt vmcnt(0)
  s_branch L_gc4
L_gok4:
  v_lshlrev_b32 v40, 16, v152
  v_and_b32 v41, 0xffff0000, v152
  v_lshlrev_b32 v42, 16, v153
  v_and_b32 v43, 0xffff0000, v153
  v_mov_b32 v24, 149712
  s_mov_b32 s13, 0
L_lw_t4:
  ds_read_b128 v[20:23], v24
  s_waitcnt lgkmcnt(0)
  v_min_u32 v20, v20, v21
  v_min_u32 v22, v22, v23
  v_min_u32 v20, v20, v22
  s_nop 0
  v_readfirstlane_b32 s7, v20
  s_add_u32 s13, s13, 1
  s_cmp_ge_u32 s7, 7
  s_cbranch_scc1 L_lwd_t4
  s_cmp_lt_u32 s13, 0x400000
  s_cbranch_scc1 L_lw_t4
L_lwd_t4:
  ds_read_b64 v[34:35], v9 offset:9216
  s_waitcnt lgkmcnt(0)
  v_lshlrev_b32 v44, 16, v34
  v_and_b32 v45, 0xffff0000, v34
  v_lshlrev_b32 v46, 16, v35
  v_and_b32 v47, 0xffff0000, v35
  v_fmac_f32 v44, v112, v60
  v_fmac_f32 v45, v113, v61
  v_fmac_f32 v46, v114, v62
  v_fmac_f32 v47, v115, v63
  v_mul_f32 v44, v44, v80
  v_mul_f32 v45, v45, v81
  v_mul_f32 v46, v46, v82
  v_mul_f32 v47, v47, v83
  v_cvt_pk_bf16_f32 v36, v44, v45
  v_cvt_pk_bf16_f32 v37, v46, v47
  v_lshlrev_b32 v44, 16, v36
  v_and_b32 v45, 0xffff0000, v36
  v_lshlrev_b32 v46, 16, v37
  v_and_b32 v47, 0xffff0000, v37
  v_sub_f32 v40, v40, v44
  v_sub_f32 v41, v41, v45
  v_sub_f32 v42, v42, v46
  v_sub_f32 v43, v43, v47
  v_fmac_f32 v44, v40, v136
  v_fmac_f32 v45, v41, v136
  v_fmac_f32 v46, v42, v136
  v_fmac_f32 v47, v43, v136
  v_cvt_pk_bf16_f32 v48, v44, v45
  v_cvt_pk_bf16_f32 v49, v46, v47
  global_store_dwordx2 v8, v[48:49], s[72:73]
  s_add_u32 s72, s72, 0x80000
  s_addc_u32 s73, s73, 0
  s_mov_b32 s13, 0
L_gc5:
  v_cmp_ne_u32 vcc, s74, v139
  s_cbranch_vccz L_gok5
  s_add_u32 s13, s13, 1
  s_cmp_lt_u32 s13, 0x10000
  s_cbranch_scc0 L_gok5
  s_sleep 8
  global_load_dwordx2 v[138:139], v18, s[48:49] offset:2048 sc1
  s_waitcnt vmcnt(0)
  s_branch L_gc5
L_gok5:
  v_lshlrev_b32 v40, 16, v154
  v_and_b32 v41, 0xffff0000, v154
  v_lshlrev_b32 v42, 16, v155
  v_and_b32 v43, 0xffff0000, v155
  v_mov_b32 v24, 149712
  s_mov_b32 s13, 0
L_lw_t5:
  ds_read_b128 v[20:23], v24
  s_waitcnt lgkmcnt(0)
  v_min_u32 v20, v20, v21
  v_min_u32 v22, v22, v23
  v_min_u32 v20, v20, v22
  s_nop 0
  v_readfirstlane_b32 s7, v20
  s_add_u32 s13, s13, 1
  s_cmp_ge_u32 s7, 8
  s_cbranch_scc1 L_lwd_t5
  s_cmp_lt_u32 s13, 0x400000
  s_cbranch_scc1 L_lw_t5
L_lwd_t5:
  ds_read_b64 v[34:35], v9 offset:11520
  s_waitcnt lgkmcnt(0)
  v_lshlrev_b32 v44, 16, v34
  v_and_b32 v45, 0xffff0000, v34
  v_lshlrev_b32 v46, 16, v35
  v_and_b32 v47, 0xffff0000, v35
  v_fmac_f32 v44, v116, v60
  v_fmac_f32 v45, v117, v61
  v_fmac_f32 v46, v118, v62
  v_fmac_f32 v47, v119, v63
  v_mul_f32 v44, v44, v84
  v_mul_f32 v45, v45, v85
  v_mul_f32 v46, v46, v86
  v_mul_f32 v47, v47, v87
  v_cvt_pk_bf16_f32 v36, v44, v45
  v_cvt_pk_bf16_f32 v37, v46, v47
  v_lshlrev_b32 v44, 16, v36
  v_and_b32 v45, 0xffff0000, v36
  v_lshlrev_b32 v46, 16, v37
  v_and_b32 v47, 0xffff0000, v37
  v_sub_f32 v40, v40, v44
  v_sub_f32 v41, v41, v45
  v_sub_f32 v42, v42, v46
  v_sub_f32 v43, v43, v47
  v_fmac_f32 v44, v40, v138
  v_fmac_f32 v45, v41, v138
  v_fmac_f32 v46, v42, v138
  v_fmac_f32 v47, v43, v138
  v_cvt_pk_bf16_f32 v50, v44, v45
  v_cvt_pk_bf16_f32 v51, v46, v47
  global_store_dwordx2 v8, v[50:51], s[72:73]
  s_add_u32 s72, s72, 0x80000
  s_addc_u32 s73, s73, 0
  s_mov_b32 s13, 0
L_gc6:
  v_cmp_ne_u32 vcc, s74, v141
  s_cbranch_vccz L_gok6
  s_add_u32 s13, s13, 1
  s_cmp_lt_u32 s13, 0x10000
  s_cbranch_scc0 L_gok6
  s_sleep 8
  global_load_dwordx2 v[140:141], v19, s[48:49] offset:0 sc1
  s_waitcnt vmcnt(0)
  s_branch L_gc6
L_gok6:
  v_lshlrev_b32 v40, 16, v156
  v_and_b32 v41, 0xffff0000, v156
  v_lshlrev_b32 v42, 16, v157
  v_and_b32 v43, 0xffff0000, v157
  v_mov_b32 v24, 149712
  s_mov_b32 s13, 0
L_lw_t6:
  ds_read_b128 v[20:23], v24
  s_waitcnt lgkmcnt(0)
  v_min_u32 v20, v20, v21
  v_min_u32 v22, v22, v23
  v_min_u32 v20, v20, v22
  s_nop 0
  v_readfirstlane_b32 s7, v20
  s_add_u32 s13, s13, 1
  s_cmp_ge_u32 s7, 9
  s_cbranch_scc1 L_lwd_t6
  s_cmp_lt_u32 s13, 0x400000
  s_cbranch_scc1 L_lw_t6
L_lwd_t6:
  ds_read_b64 v[34:35], v9 offset:13824
  s_waitcnt lgkmcnt(0)
  v_lshlrev_b32 v44, 16, v34
  v_and_b32 v45, 0xffff0000, v34
  v_lshlrev_b32 v46, 16, v35
  v_and_b32 v47, 0xffff0000, v35
  v_fmac_f32 v44, v120, v60
  v_fmac_f32 v45, v121, v61
  v_fmac_f32 v46, v122, v62
  v_fmac_f32 v47, v123, v63
  v_mul_f32 v44, v44, v88
  v_mul_f32 v45, v45, v89
  v_mul_f32 v46, v46, v90
  v_mul_f32 v47, v47, v91
  v_cvt_pk_bf16_f32 v36, v44, v45
  v_cvt_pk_bf16_f32 v37, v46, v47
  v_lshlrev_b32 v44, 16, v36
  v_and_b32 v45, 0xffff0000, v36
  v_lshlrev_b32 v46, 16, v37
  v_and_b32 v47, 0xffff0000, v37
  v_sub_f32 v40, v40, v44
  v_sub_f32 v41, v41, v45
  v_sub_f32 v42, v42, v46
  v_sub_f32 v43, v43, v47
  v_fmac_f32 v44, v40, v140
  v_fmac_f32 v45, v41, v140
  v_fmac_f32 v46, v42, v140
  v_fmac_f32 v47, v43, v140
  v_cvt_pk_bf16_f32 v48, v44, v45
  v_cvt_pk_bf16_f32 v49, v46, v47
  global_store_dwordx2 v8, v[48:49], s[72:73]
  s_add_u32 s72, s72, 0x80000
  s_addc_u32 s73, s73, 0
  s_mov_b32 s13, 0
L_gc7:
  v_cmp_ne_u32 vcc, s74, v143
  s_cbranch_vccz L_gok7
  s_add_u32 s13, s13, 1
  s_cmp_lt_u32 s13, 0x10000
  s_cbranch_scc0 L_gok7
  s_sleep 8
  global_load_dwordx2 v[142:143], v19, s[48:49] offset:2048 sc1
  s_waitcnt vmcnt(0)
  s_branch L_gc7
L_gok7:
  v_lshlrev_b32 v40, 16, v158
  v_and_b32 v41, 0xffff0000, v158
  v_lshlrev_b32 v42, 16, v159
  v_and_b32 v43, 0xffff0000, v159
  v_mov_b32 v24, 149712
  s_mov_b32 s13, 0
L_lw_t7:
  ds_read_b128 v[20:23], v24
  s_waitcnt lgkmcnt(0)
  v_min_u32 v20, v20, v21
  v_min_u32 v22, v22, v23
  v_min_u32 v20, v20, v22
  s_nop 0
  v_readfirstlane_b32 s7, v20
  s_add_u32 s13, s13, 1
  s_cmp_ge_u32 s7, 10
  s_cbranch_scc1 L_lwd_t7
  s_cmp_lt_u32 s13, 0x400000
  s_cbranch_scc1 L_lw_t7
L_lwd_t7:
  ds_read_b64 v[34:35], v9 offset:16128
  s_waitcnt lgkmcnt(0)
  v_lshlrev_b32 v44, 16, v34
  v_and_b32 v45, 0xffff0000, v34
  v_lshlrev_b32 v46, 16, v35
  v_and_b32 v47, 0xffff0000, v35
  v_fmac_f32 v44, v124, v60
  v_fmac_f32 v45, v125, v61
  v_fmac_f32 v46, v126, v62
  v_fmac_f32 v47, v127, v63
  v_mul_f32 v44, v44, v92
  v_mul_f32 v45, v45, v93
  v_mul_f32 v46, v46, v94
  v_mul_f32 v47, v47, v95
  v_cvt_pk_bf16_f32 v36, v44, v45
  v_cvt_pk_bf16_f32 v37, v46, v47
  v_lshlrev_b32 v44, 16, v36
  v_and_b32 v45, 0xffff0000, v36
  v_lshlrev_b32 v46, 16, v37
  v_and_b32 v47, 0xffff0000, v37
  v_sub_f32 v40, v40, v44
  v_sub_f32 v41, v41, v45
  v_sub_f32 v42, v42, v46
  v_sub_f32 v43, v43, v47
  v_fmac_f32 v44, v40, v142
  v_fmac_f32 v45, v41, v142
  v_fmac_f32 v46, v42, v142
  v_fmac_f32 v47, v43, v142
  v_cvt_pk_bf16_f32 v50, v44, v45
  v_cvt_pk_bf16_f32 v51, v46, v47
  global_store_dwordx2 v8, v[50:51], s[72:73]
  s_add_u32 s72, s72, 0x80000
  s_addc_u32 s73, s73, 0
  s_branch L_done
L_Brest:
  s_waitcnt lgkmcnt(0)
  s_waitcnt lgkmcnt(0)
  s_lshl_b32 s7, s6, 2
  s_add_u32 s7, s7, 149712
  v_mov_b32 v20, s7
  v_mov_b32 v21, 1
  ds_write_b32 v20, v21
  s_waitcnt vmcnt(0)
  ds_write_b128 v98, v[128:131] offset:432
  ds_write_b128 v98, v[144:147] offset:5040
  ds_write_b128 v98, v[132:135] offset:1584
  ds_write_b128 v98, v[148:151] offset:6192
  ds_write_b128 v98, v[136:139] offset:2736
  ds_write_b128 v98, v[152:155] offset:7344
  ds_write_b128 v98, v[140:143] offset:3888
  ds_write_b128 v98, v[156:159] offset:8496
  v_cmp_gt_u32 vcc, 24, v2
  s_nop 0
  s_and_saveexec_b64 s[56:57], vcc
  ds_write_b128 v98, v[224:227] offset:0
  s_mov_b64 exec, s[56:57]
  v_readfirstlane_b32 s75, v107
  s_nop 0
  s_mul_i32 s74, s75, 0x9e3779b1
  s_add_u32 s74, s74, 0x7f4a7c15
  v_alignbit_b32 v228, v228, v228, 16
  v_alignbit_b32 v229, v229, v229, 16
  v_alignbit_b32 v230, v230, v230, 16
  v_alignbit_b32 v231, v231, v231, 16
  v_alignbit_b32 v232, v232, v232, 16
  v_alignbit_b32 v233, v233, v233, 16
  v_alignbit_b32 v234, v234, v234, 16
  v_alignbit_b32 v235, v235, v235, 16
  ds_read_b64_tr_b16 v[16:17], v169 offset:0
  ds_read_b64_tr_b16 v[18:19], v169 offset:576
  ds_read_b64_tr_b16 v[20:21], v169 offset:1152
  ds_read_b64_tr_b16 v[22:23], v169 offset:1728
  ds_read_b64_tr_b16 v[24:25], v169 offset:2304
  ds_read_b64_tr_b16 v[26:27], v169 offset:2880
  ds_read_b64_tr_b16 v[28:29], v169 offset:3456
  ds_read_b64_tr_b16 v[30:31], v169 offset:4032
  ds_read_b64_tr_b16 v[80:81], v168 offset:5040
  ds_read_b64_tr_b16 v[82:83], v168 offset:7344
  ds_read_b64_tr_b16 v[32:33], v169 offset:32
  ds_read_b64_tr_b16 v[34:35], v169 offset:608
  ds_read_b64_tr_b16 v[36:37], v169 offset:1184
  ds_read_b64_tr_b16 v[38:39], v169 offset:1760
  ds_read_b64_tr_b16 v[40:41], v169 offset:2336
  ds_read_b64_tr_b16 v[42:43], v169 offset:2912
  ds_read_b64_tr_b16 v[44:45], v169 offset:3488
  ds_read_b64_tr_b16 v[46:47], v169 offset:4064
  ds_read_b64_tr_b16 v[84:85], v168 offset:5072
  ds_read_b64_tr_b16 v[86:87], v168 offset:7376
  ds_read_b64_tr_b16 v[48:49], v169 offset:64
  ds_read_b64_tr_b16 v[50:51], v169 offset:640
  ds_read_b64_tr_b16 v[52:53], v169 offset:1216
  ds_read_b64_tr_b16 v[54:55], v169 offset:1792
  ds_read_b64_tr_b16 v[56:57], v169 offset:2368
  ds_read_b64_tr_b16 v[58:59], v169 offset:2944
  ds_read_b64_tr_b16 v[60:61], v169 offset:3520
  ds_read_b64_tr_b16 v[62:63], v169 offset:4096
  ds_read_b64_tr_b16 v[88:89], v168 offset:5104
  ds_read_b64_tr_b16 v[90:91], v168 offset:7408
  ds_read_b64_tr_b16 v[64:65], v169 offset:96
  ds_read_b64_tr_b16 v[66:67], v169 offset:672
  ds_read_b64_tr_b16 v[68:69], v169 offset:1248
  ds_read_b64_tr_b16 v[70:71], v169 offset:1824
  ds_read_b64_tr_b16 v[72:73], v169 offset:2400
  ds_read_b64_tr_b16 v[74:75], v169 offset:2976
  ds_read_b64_tr_b16 v[76:77], v169 offset:3552
  ds_read_b64_tr_b16 v[78:79], v169 offset:4128
  ds_read_b64_tr_b16 v[92:93], v168 offset:5136
  ds_read_b64_tr_b16 v[94:95], v168 offset:7440
  s_waitcnt lgkmcnt(15)
  v_dot2_f32_bf16 v16, v16, v229, 0
  v_dot2_f32_bf16 v18, v18, v229, 0
  v_dot2_f32_bf16 v20, v20, v229, 0
  v_dot2_f32_bf16 v22, v22, v229, 0
  v_dot2_f32_bf16 v24, v24, v229, 0
  v_dot2_f32_bf16 v26, v26, v229, 0
  v_dot2_f32_bf16 v28, v28, v229, 0
  v_dot2_f32_bf16 v30, v30, v229, 0
  v_dot2c_f32_bf16 v16, v17, v228
  v_dot2c_f32_bf16 v18, v19, v228
  v_dot2c_f32_bf16 v20, v21, v228
  v_dot2c_f32_bf16 v22, v23, v228
  v_dot2c_f32_bf16 v24, v25, v228
  v_dot2c_f32_bf16 v26, v27, v228
  v_dot2c_f32_bf16 v28, v29, v228
  v_dot2c_f32_bf16 v30, v31, v228
  v_lshlrev_b32 v17, 16, v80
  v_and_b32 v19, 0xffff0000, v80
  v_lshlrev_b32 v21, 16, v81
  v_and_b32 v23, 0xffff0000, v81
  v_lshlrev_b32 v25, 16, v82
  v_and_b32 v27, 0xffff0000, v82
  v_lshlrev_b32 v29, 16, v83
  v_and_b32 v31, 0xffff0000, v83
  v_mul_f32 v16, v16, v17
  v_mul_f32 v18, v18, v19
  v_mul_f32 v20, v20, v21
  v_mul_f32 v22, v22, v23
  v_mul_f32 v24, v24, v25
  v_mul_f32 v26, v26, v27
  v_mul_f32 v28, v28, v29
  v_mul_f32 v30, v30, v31
  v_cvt_pk_bf16_f32 v96, v16, v18
  v_cvt_pk_bf16_f32 v97, v20, v22
  v_cvt_pk_bf16_f32 v98, v24, v26
  v_cvt_pk_bf16_f32 v99, v28, v30
  global_store_dwordx4 v170, v[96:99], s[54:55] sc1
  v_dot2_f32_bf16 v32, v32, v231, 0
  v_dot2_f32_bf16 v34, v34, v231, 0
  v_dot2_f32_bf16 v36, v36, v231, 0
  v_dot2_f32_bf16 v38, v38, v231, 0
  v_dot2_f32_bf16 v40, v40, v231, 0
  v_dot2_f32_bf16 v42, v42, v231, 0
  v_dot2_f32_bf16 v44, v44, v231, 0
  v_dot2_f32_bf16 v46, v46, v231, 0
  v_dot2c_f32_bf16 v32, v33, v230
  v_dot2c_f32_bf16 v34, v35, v230
  v_dot2c_f32_bf16 v36, v37, v230
  v_dot2c_f32_bf16 v38, v39, v230
  v_dot2c_f32_bf16 v40, v41, v230
  v_dot2c_f32_bf16 v42, v43, v230
  v_dot2c_f32_bf16 v44, v45, v230
  v_dot2c_f32_bf16 v46, v47, v230
  v_lshlrev_b32 v33, 16, v84
  v_and_b32 v35, 0xffff0000, v84
  v_lshlrev_b32 v37, 16, v85
  v_and_b32 v39, 0xffff0000, v85
  v_lshlrev_b32 v41, 16, v86
  v_and_b32 v43, 0xffff0000, v86
  v_lshlrev_b32 v45, 16, v87
  v_and_b32 v47, 0xffff0000, v87
  v_mul_f32 v32, v32, v33
  v_mul_f32 v34, v34, v35
  v_mul_f32 v36, v36, v37
  v_mul_f32 v38, v38, v39
  v_mul_f32 v40, v40, v41
  v_mul_f32 v42, v42, v43
  v_mul_f32 v44, v44, v45
  v_mul_f32 v46, v46, v47
  v_cvt_pk_bf16_f32 v100, v32, v34
  v_cvt_pk_bf16_f32 v101, v36, v38
  v_cvt_pk_bf16_f32 v102, v40, v42
  v_cvt_pk_bf16_f32 v103, v44, v46
  v_add_u32 v4, 65536, v170
  global_store_dwordx4 v4, v[100:103], s[54:55] sc1
  v_dot2_f32_bf16 v48, v48, v233, 0
  v_dot2_f32_bf16 v50, v50, v233, 0
  v_dot2_f32_bf16 v52, v52, v233, 0
  v_dot2_f32_bf16 v54, v54, v233, 0
  v_dot2_f32_bf16 v56, v56, v233, 0
  s_waitcnt lgkmcnt(14)
  v_dot2_f32_bf16 v58, v58, v233, 0
  s_waitcnt lgkmcnt(13)
  v_dot2_f32_bf16 v60, v60, v233, 0
  s_waitcnt lgkmcnt(12)
  v_dot2_f32_bf16 v62, v62, v233, 0
  v_dot2c_f32_bf16 v48, v49, v232
  v_dot2c_f32_bf16 v50, v51, v232
  v_dot2c_f32_bf16 v52, v53, v232
  v_dot2c_f32_bf16 v54, v55, v232
  v_dot2c_f32_bf16 v56, v57, v232
  v_dot2c_f32_bf16 v58, v59, v232
  v_dot2c_f32_bf16 v60, v61, v232
  v_dot2c_f32_bf16 v62, v63, v232
  s_waitcnt lgkmcnt(11)
  v_lshlrev_b32 v49, 16, v88
  v_and_b32 v51, 0xffff0000, v88
  v_lshlrev_b32 v53, 16, v89
  v_and_b32 v55, 0xffff0000, v89
  s_waitcnt lgkmcnt(10)
  v_lshlrev_b32 v57, 16, v90
  v_and_b32 v59, 0xffff0000, v90
  v_lshlrev_b32 v61, 16, v91
  v_and_b32 v63, 0xffff0000, v91
  v_mul_f32 v48, v48, v49
  v_mul_f32 v50, v50, v51
  v_mul_f32 v52, v52, v53
  v_mul_f32 v54, v54, v55
  v_mul_f32 v56, v56, v57
  v_mul_f32 v58, v58, v59
  v_mul_f32 v60, v60, v61
  v_mul_f32 v62, v62, v63
  v_cvt_pk_bf16_f32 v104, v48, v50
  v_cvt_pk_bf16_f32 v105, v52, v54
  v_cvt_pk_bf16_f32 v106, v56, v58
  v_cvt_pk_bf16_f32 v107, v60, v62
  v_add_u32 v4, 131072, v170
  global_store_dwordx4 v4, v[104:107], s[54:55] sc1
  s_waitcnt lgkmcnt(9)
  v_dot2_f32_bf16 v64, v64, v235, 0
  s_waitcnt lgkmcnt(8)
  v_dot2_f32_bf16 v66, v66, v235, 0
  s_waitcnt lgkmcnt(7)
  v_dot2_f32_bf16 v68, v68, v235, 0
  s_waitcnt lgkmcnt(6)
  v_dot2_f32_bf16 v70, v70, v235, 0
  s_waitcnt lgkmcnt(5)
  v_dot2_f32_bf16 v72, v72, v235, 0
  s_waitcnt lgkmcnt(4)
  v_dot2_f32_bf16 v74, v74, v235, 0
  s_waitcnt lgkmcnt(3)
  v_dot2_f32_bf16 v76, v76, v235, 0
  s_waitcnt lgkmcnt(2)
  v_dot2_f32_bf16 v78, v78, v235, 0
  v_dot2c_f32_bf16 v64, v65, v234
  v_dot2c_f32_bf16 v66, v67, v234
  v_dot2c_f32_bf16 v68, v69, v234
  v_dot2c_f32_bf16 v70, v71, v234
  v_dot2c_f32_bf16 v72, v73, v234
  v_dot2c_f32_bf16 v74, v75, v234
  v_dot2c_f32_bf16 v76, v77, v234
  v_dot2c_f32_bf16 v78, v79, v234
  s_waitcnt lgkmcnt(1)
  v_lshlrev_b32 v65, 16, v92
  v_and_b32 v67, 0xffff0000, v92
  v_lshlrev_b32 v69, 16, v93
  v_and_b32 v71, 0xffff0000, v93
  s_waitcnt lgkmcnt(0)
  v_lshlrev_b32 v73, 16, v94
  v_and_b32 v75, 0xffff0000, v94
  v_lshlrev_b32 v77, 16, v95
  v_and_b32 v79, 0xffff0000, v95
  v_mul_f32 v64, v64, v65
  v_mul_f32 v66, v66, v67
  v_mul_f32 v68, v68, v69
  v_mul_f32 v70, v70, v71
  v_mul_f32 v72, v72, v73
  v_mul_f32 v74, v74, v75
  v_mul_f32 v76, v76, v77
  v_mul_f32 v78, v78, v79
  v_cvt_pk_bf16_f32 v108, v64, v66
  v_cvt_pk_bf16_f32 v109, v68, v70
  v_cvt_pk_bf16_f32 v110, v72, v74
  v_cvt_pk_bf16_f32 v111, v76, v78
  v_add_u32 v4, 196608, v170
  global_store_dwordx4 v4, v[108:111], s[54:55] sc1
  s_waitcnt lgkmcnt(0)
  s_lshl_b32 s7, s6, 2
  s_add_u32 s7, s7, 149696
  v_mov_b32 v20, s7
  v_mov_b32 v21, 1
  ds_write_b32 v20, v21
  s_waitcnt vmcnt(0)
  s_lshl_b32 s7, s4, 1
  s_add_u32 s7, s7, 1
  s_lshl_b32 s7, s7, 4
  s_add_u32 s7, s7, s5
  s_lshl_b32 s7, s7, 2
  s_add_u32 s7, s7, s63
  s_lshl_b32 s7, s7, 4
  v_mov_b32 v172, s7
  v_mov_b32 v173, s74
  s_mov_b64 exec, 1
  global_store_dword v172, v173, s[48:49] sc1
  s_mov_b64 exec, -1
  global_load_dwordx4 v[108:111], v14, s[38:39] offset:0 nt
  global_load_dwordx4 v[112:115], v14, s[38:39] offset:1024 nt
  global_load_dwordx4 v[116:119], v14, s[38:39] offset:2048 nt
  global_load_dwordx4 v[120:123], v14, s[38:39] offset:3072 nt
  s_waitcnt vmcnt(0)
  s_mul_i32 s7, s6, 4128
  v_add_u32 v7, s7, v10
  ds_write_b128 v7, v[108:111] offset:32
  ds_write_b128 v7, v[112:115] offset:1056
  ds_write_b128 v7, v[116:119] offset:2080
  ds_write_b128 v7, v[120:123] offset:3104
  v_and_b32 v16, 3, v2
  v_bfe_u32 v17, v2, 2, 2
  v_sub_u32 v16, v16, v17
  v_lshlrev_b32 v16, 3, v16
  v_lshrrev_b32 v17, 4, v2
  v_lshlrev_b32 v17, 6, v17
  v_sub_u32 v16, v16, v17
  s_mul_i32 s7, s6, 4128
  s_add_u32 s7, s7, 224
  v_add_u32 v16, s7, v16
  ds_read_b64_tr_b16 v[64:65], v16 offset:32
  ds_read_b64_tr_b16 v[66:67], v16 offset:0
  ds_read_b64_tr_b16 v[68:69], v16 offset:288
  ds_read_b64_tr_b16 v[70:71], v16 offset:256
  ds_read_b64_tr_b16 v[72:73], v16 offset:544
  ds_read_b64_tr_b16 v[74:75], v16 offset:512
  ds_read_b64_tr_b16 v[76:77], v16 offset:800
  ds_read_b64_tr_b16 v[78:79], v16 offset:768
  ds_read_b64_tr_b16 v[80:81], v16 offset:1056
  ds_read_b64_tr_b16 v[82:83], v16 offset:1024
  ds_read_b64_tr_b16 v[84:85], v16 offset:1312
  ds_read_b64_tr_b16 v[86:87], v16 offset:1280
  ds_read_b64_tr_b16 v[88:89], v16 offset:1568
  ds_read_b64_tr_b16 v[90:91], v16 offset:1536
  ds_read_b64_tr_b16 v[92:93], v16 offset:1824
  ds_read_b64_tr_b16 v[94:95], v16 offset:1792
  ds_read_b64_tr_b16 v[96:97], v16 offset:2080
  ds_read_b64_tr_b16 v[98:99], v16 offset:2048
  ds_read_b64_tr_b16 v[100:101], v16 offset:2336
  ds_read_b64_tr_b16 v[102:103], v16 offset:2304
  ds_read_b64_tr_b16 v[104:105], v16 offset:2592
  ds_read_b64_tr_b16 v[106:107], v16 offset:2560
  ds_read_b64_tr_b16 v[108:109], v16 offset:2848
  ds_read_b64_tr_b16 v[110:111], v16 offset:2816
  ds_read_b64_tr_b16 v[112:113], v16 offset:3104
  ds_read_b64_tr_b16 v[114:115], v16 offset:3072
  ds_read_b64_tr_b16 v[116:117], v16 offset:3360
  ds_read_b64_tr_b16 v[118:119], v16 offset:3328
  ds_read_b64_tr_b16 v[120:121], v16 offset:3616
  ds_read_b64_tr_b16 v[122:123], v16 offset:3584
  ds_read_b64_tr_b16 v[124:125], v16 offset:3872
  ds_read_b64_tr_b16 v[126:127], v16 offset:3840
  s_cmp_eq_u32 s63, 0
  s_cbranch_scc0 L_pwk
  s_lshl_b32 s7, s4, 1
  s_add_u32 s7, s7, 1
  s_lshl_b32 s7, s7, 10
  v_lshlrev_b32 v6, 4, v2
  v_add_u32 v6, s7, v6
  s_mov_b32 s13, 0
L_pollk:
  global_load_dword v5, v6, s[48:49] sc1
  s_waitcnt vmcnt(0)
  v_cmp_ne_u32 vcc, s74, v5
  s_cbranch_vccz L_polledk
  s_add_u32 s13, s13, 1
  s_cmp_lt_u32 s13, 0x40000
  s_cbranch_scc0 L_polledk
  s_sleep 2
  s_branch L_pollk
L_polledk:
  v_mov_b32 v6, 149760
  v_mov_b32 v20, 1
  v_mov_b32 v21, 1
  v_mov_b32 v22, 1
  v_mov_b32 v23, 1
  ds_write_b128 v6, v[20:23]
  s_branch L_pdk
L_pwk:
  v_mov_b32 v24, 149760
  s_mov_b32 s13, 0
L_lw_pk:
  ds_read_b128 v[20:23], v24
  s_waitcnt lgkmcnt(0)
  v_min_u32 v20, v20, v21
  v_min_u32 v22, v22, v23
  v_min_u32 v20, v20, v22
  s_nop 0
  v_readfirstlane_b32 s7, v20
  s_add_u32 s13, s13, 1
  s_cmp_ge_u32 s7, 1
  s_cbranch_scc1 L_lwd_pk
  s_cmp_lt_u32 s13, 0x400000
  s_cbranch_scc1 L_lw_pk
L_lwd_pk:
L_pdk:
  s_waitcnt lgkmcnt(0)
  s_lshl_b32 s7, s4, 18
  s_lshl_b32 s8, s5, 14
  s_add_u32 s7, s7, s8
  s_lshl_b32 s8, s63, 12
  s_add_u32 s7, s7, s8
  s_add_u32 s7, s7, 5242880
  s_add_u32 s68, s48, s7
  s_addc_u32 s69, s49, 0
  v_lshlrev_b32 v7, 4, v2
  global_load_dwordx4 v[32:35], v7, s[68:69] offset:0 sc1
  global_load_dwordx4 v[36:39], v7, s[68:69] offset:1024 sc1
  global_load_dwordx4 v[40:43], v7, s[68:69] offset:2048 sc1
  global_load_dwordx4 v[44:47], v7, s[68:69] offset:3072 sc1
  s_mul_i32 s7, s63, 4672
  s_add_u32 s7, s7, 57728
  v_and_b32 v0, 3, v2
  v_mul_u32_u24 v0, 1168, v0
  v_lshrrev_b32 v7, 4, v2
  v_lshl_add_u32 v0, v7, 6, v0
  v_bfe_u32 v7, v2, 2, 2
  v_lshl_add_u32 v0, v7, 4, v0
  v_add_u32 v0, s7, v0
  v_and_b32 v20, 15, v2
  v_lshrrev_b32 v21, 4, v2
  s_mul_i32 s7, s63, 4672
  s_add_u32 s8, s7, 57608
  v_lshlrev_b32 v3, 3, v20
  v_lshl_add_u32 v3, v21, 4, v3
  v_add_u32 v3, s8, v3
  s_add_u32 s8, s7, 131136
  v_lshlrev_b32 v4, 3, v20
  v_lshl_add_u32 v4, v21, 1, v4
  v_add_u32 v4, s8, v4
  s_lshl_b32 s8, s63, 1
  s_add_u32 s8, s8, 33024
  v_mul_u32_u24 v5, 576, v21
  v_lshl_add_u32 v5, v20, 3, v5
  v_add_u32 v5, s8, v5
  v_subrev_u32 v7, 16, v2
  v_add_u32 v23, 47, v2
  v_cmp_gt_u32 vcc, 16, v2
  s_nop 1
  v_cndmask_b32 v7, v7, v23, vcc
  v_cmp_eq_u32 s[70:71], 0, v2
  v_mov_b32 v23, 63
  s_nop 0
  v_cndmask_b32 v7, v7, v23, s[70:71]
  v_lshlrev_b32 v7, 2, v7
  v_mov_b32 v12, 0
  v_mov_b32 v13, 0
  v_mov_b32 v14, 0
  v_mov_b32 v15, 0
  v_mov_b32 v16, 0
  v_mov_b32 v17, 0
  v_mov_b32 v18, 0
  v_mov_b32 v19, 0
  v_mov_b32 v27, 0
  v_mov_b32 v28, 0
  v_mov_b32 v29, 0
  v_mov_b32 v30, 0
  v_mov_b32 v31, 0
  v_mov_b32 v11, 0
  v_mov_b32 v24, 149696
  s_mov_b32 s13, 0
L_lw_b1:
  ds_read_b128 v[20:23], v24
  s_waitcnt lgkmcnt(0)
  v_min_u32 v20, v20, v21
  v_min_u32 v22, v22, v23
  v_min_u32 v20, v20, v22
  s_nop 0
  v_readfirstlane_b32 s7, v20
  s_add_u32 s13, s13, 1
  s_cmp_ge_u32 s7, 1
  s_cbranch_scc1 L_lwd_b1
  s_cmp_lt_u32 s13, 0x400000
  s_cbranch_scc1 L_lw_b1
L_lwd_b1:
  v_mov_b32 v16, 0
  v_mov_b32 v17, 0
  v_mov_b32 v18, 0
  v_mov_b32 v19, 0
  v_bfe_u32 v20, v2, 3, 2
  v_mul_u32_u24 v20, 1168, v20
  v_and_b32 v21, 7, v2
  v_lshl_add_u32 v20, v21, 4, v20
  s_mul_i32 s7, s63, 4672
  s_add_u32 s7, s7, 57600
  v_add_u32 v20, s7, v20
  ds_write_b128 v20, v[16:19]
  s_cmp_eq_u32 s6, 4
  s_cbranch_scc0 L_noarr
  v_mov_b32 v24, 149712
  s_mov_b32 s13, 0
L_lw_arr:
  ds_read_b128 v[20:23], v24
  s_waitcnt lgkmcnt(0)
  v_min_u32 v20, v20, v21
  v_min_u32 v22, v22, v23
  v_min_u32 v20, v20, v22
  s_nop 0
  v_readfirstlane_b32 s7, v20
  s_add_u32 s13, s13, 1
  s_cmp_ge_u32 s7, 1
  s_cbranch_scc1 L_lwd_arr
  s_cmp_lt_u32 s13, 0x400000
  s_cbranch_scc1 L_lw_arr
L_lwd_arr:
  s_mov_b64 exec, 1
  v_mov_b32 v9, 0
  v_mov_b32 v1, 1
  global_atomic_add v8, v9, v1, s[46:47] sc0
  s_mov_b64 exec, -1
  s_waitcnt vmcnt(1)
  s_branch L_arrd
L_noarr:
  s_waitcnt vmcnt(0)
L_arrd:
  ds_write_b128 v0, v[32:35] offset:0
  ds_write_b128 v0, v[36:39] offset:256
  ds_write_b128 v0, v[40:43] offset:512
  ds_write_b128 v0, v[44:47] offset:768
  s_lshl_b32 s7, s6, 2
  s_add_u32 s7, s7, 149696
  v_mov_b32 v6, s7
  v_mov_b32 v4, 2
  ds_write_b32 v6, v4
  s_waitcnt lgkmcnt(0)
  ds_read_b64 v[32:33], v3 offset:0
  ds_read_b64 v[34:35], v3 offset:8
  ds_read_b64 v[36:37], v3 offset:1168
  ds_read_b64 v[38:39], v3 offset:1176
  ds_read_b64 v[40:41], v3 offset:2336
  ds_read_b64 v[42:43], v3 offset:2344
  ds_read_b64 v[44:45], v3 offset:3504
  ds_read_b64 v[46:47], v3 offset:3512
  s_waitcnt lgkmcnt(6)
  v_mfma_f32_16x16x32_bf16 v[128:131], v[68:71], v[32:35], 0
  ds_read_b64 v[48:49], v3 offset:64
  ds_read_b64 v[50:51], v3 offset:72
  v_mfma_f32_16x16x32_bf16 v[144:147], v[76:79], v[32:35], 0
  ds_read_b64 v[52:53], v3 offset:1232
  ds_read_b64 v[54:55], v3 offset:1240
  v_mfma_f32_16x16x32_bf16 v[160:163], v[84:87], v[32:35], 0
  ds_read_b64 v[56:57], v3 offset:2400
  ds_read_b64 v[58:59], v3 offset:2408
  v_mfma_f32_16x16x32_bf16 v[176:179], v[92:95], v[32:35], 0
  ds_read_b64 v[60:61], v3 offset:3568
  ds_read_b64 v[62:63], v3 offset:3576
  v_mfma_f32_16x16x32_bf16 v[192:195], v[100:103], v[32:35], 0
  v_mfma_f32_16x16x32_bf16 v[208:211], v[108:111], v[32:35], 0
  v_mfma_f32_16x16x32_bf16 v[224:227], v[116:119], v[32:35], 0
  v_mfma_f32_16x16x32_bf16 v[240:243], v[124:127], v[32:35], 0
  s_waitcnt lgkmcnt(12)
  v_mfma_f32_16x16x32_bf16 v[132:135], v[68:71], v[36:39], 0
  v_mfma_f32_16x16x32_bf16 v[148:151], v[76:79], v[36:39], 0
  v_mfma_f32_16x16x32_bf16 v[164:167], v[84:87], v[36:39], 0
  v_mfma_f32_16x16x32_bf16 v[180:183], v[92:95], v[36:39], 0
  v_mfma_f32_16x16x32_bf16 v[196:199], v[100:103], v[36:39], 0
  v_mfma_f32_16x16x32_bf16 v[212:215], v[108:111], v[36:39], 0
  v_mfma_f32_16x16x32_bf16 v[228:231], v[116:119], v[36:39], 0
  v_mfma_f32_16x16x32_bf16 v[244:247], v[124:127], v[36:39], 0
  s_waitcnt lgkmcnt(10)
  v_mfma_f32_16x16x32_bf16 v[136:139], v[68:71], v[40:43], 0
  v_mfma_f32_16x16x32_bf16 v[152:155], v[76:79], v[40:43], 0
  v_mfma_f32_16x16x32_bf16 v[168:171], v[84:87], v[40:43], 0
  v_mfma_f32_16x16x32_bf16 v[184:187], v[92:95], v[40:43], 0
  v_mfma_f32_16x16x32_bf16 v[200:203], v[100:103], v[40:43], 0
  v_mfma_f32_16x16x32_bf16 v[216:219], v[108:111], v[40:43], 0
  v_mfma_f32_16x16x32_bf16 v[232:235], v[116:119], v[40:43], 0
  v_mfma_f32_16x16x32_bf16 v[248:251], v[124:127], v[40:43], 0
  s_waitcnt lgkmcnt(8)
  v_mfma_f32_16x16x32_bf16 v[140:143], v[68:71], v[44:47], 0
  v_mfma_f32_16x16x32_bf16 v[156:159], v[76:79], v[44:47], 0
  v_mfma_f32_16x16x32_bf16 v[172:175], v[84:87], v[44:47], 0
  v_mfma_f32_16x16x32_bf16 v[188:191], v[92:95], v[44:47], 0
  v_mfma_f32_16x16x32_bf16 v[204:207], v[100:103], v[44:47], 0
  v_mfma_f32_16x16x32_bf16 v[220:223], v[108:111], v[44:47], 0
  v_mfma_f32_16x16x32_bf16 v[236:239], v[116:119], v[44:47], 0
  v_mfma_f32_16x16x32_bf16 v[252:255], v[124:127], v[44:47], 0
  s_waitcnt lgkmcnt(6)
  v_mfma_f32_16x16x32_bf16 v[128:131], v[64:67], v[48:51], v[128:131]
  ds_read_b64 v[32:33], v3 offset:128
  ds_read_b64 v[34:35], v3 offset:136
  v_mfma_f32_16x16x32_bf16 v[144:147], v[72:75], v[48:51], v[144:147]
  ds_read_b64 v[36:37], v3 offset:1296
  ds_read_b64 v[38:39], v3 offset:1304
  v_mfma_f32_16x16x32_bf16 v[160:163], v[80:83], v[48:51], v[160:163]
  ds_read_b64 v[40:41], v3 offset:2464
  ds_read_b64 v[42:43], v3 offset:2472
  v_mfma_f32_16x16x32_bf16 v[176:179], v[88:91], v[48:51], v[176:179]
  ds_read_b64 v[44:45], v3 offset:3632
  ds_read_b64 v[46:47], v3 offset:3640
  v_mfma_f32_16x16x32_bf16 v[192:195], v[96:99], v[48:51], v[192:195]
  v_mfma_f32_16x16x32_bf16 v[208:211], v[104:107], v[48:51], v[208:211]
  v_mfma_f32_16x16x32_bf16 v[224:227], v[112:115], v[48:51], v[224:227]
  v_mfma_f32_16x16x32_bf16 v[240:243], v[120:123], v[48:51], v[240:243]
  s_waitcnt lgkmcnt(12)
  v_mfma_f32_16x16x32_bf16 v[132:135], v[64:67], v[52:55], v[132:135]
  v_mfma_f32_16x16x32_bf16 v[148:151], v[72:75], v[52:55], v[148:151]
  v_mfma_f32_16x16x32_bf16 v[164:167], v[80:83], v[52:55], v[164:167]
  v_mfma_f32_16x16x32_bf16 v[180:183], v[88:91], v[52:55], v[180:183]
  v_mfma_f32_16x16x32_bf16 v[196:199], v[96:99], v[52:55], v[196:199]
  v_mfma_f32_16x16x32_bf16 v[212:215], v[104:107], v[52:55], v[212:215]
  v_mfma_f32_16x16x32_bf16 v[228:231], v[112:115], v[52:55], v[228:231]
  v_mfma_f32_16x16x32_bf16 v[244:247], v[120:123], v[52:55], v[244:247]
  s_waitcnt lgkmcnt(10)
  v_mfma_f32_16x16x32_bf16 v[136:139], v[64:67], v[56:59], v[136:139]
  v_mfma_f32_16x16x32_bf16 v[152:155], v[72:75], v[56:59], v[152:155]
  v_mfma_f32_16x16x32_bf16 v[168:171], v[80:83], v[56:59], v[168:171]
  v_mfma_f32_16x16x32_bf16 v[184:187], v[88:91], v[56:59], v[184:187]
  v_mfma_f32_16x16x32_bf16 v[200:203], v[96:99], v[56:59], v[200:203]
  v_mfma_f32_16x16x32_bf16 v[216:219], v[104:107], v[56:59], v[216:219]
  v_mfma_f32_16x16x32_bf16 v[232:235], v[112:115], v[56:59], v[232:235]
  v_mfma_f32_16x16x32_bf16 v[248:251], v[120:123], v[56:59], v[248:251]
  s_waitcnt lgkmcnt(8)
  v_mfma_f32_16x16x32_bf16 v[140:143], v[64:67], v[60:63], v[140:143]
  v_mfma_f32_16x16x32_bf16 v[156:159], v[72:75], v[60:63], v[156:159]
  v_mfma_f32_16x16x32_bf16 v[172:175], v[80:83], v[60:63], v[172:175]
  v_mfma_f32_16x16x32_bf16 v[188:191], v[88:91], v[60:63], v[188:191]
  v_mfma_f32_16x16x32_bf16 v[204:207], v[96:99], v[60:63], v[204:207]
  v_mfma_f32_16x16x32_bf16 v[220:223], v[104:107], v[60:63], v[220:223]
  v_mfma_f32_16x16x32_bf16 v[236:239], v[112:115], v[60:63], v[236:239]
  v_mfma_f32_16x16x32_bf16 v[252:255], v[120:123], v[60:63], v[252:255]
  s_waitcnt lgkmcnt(6)
  v_mfma_f32_16x16x32_bf16 v[144:147], v[68:71], v[32:35], v[144:147]
  ds_read_b64 v[48:49], v3 offset:192
  ds_read_b64 v[50:51], v3 offset:200
  v_mfma_f32_16x16x32_bf16 v[160:163], v[76:79], v[32:35], v[160:163]
  ds_read_b64 v[52:53], v3 offset:1360
  ds_read_b64 v[54:55], v3 offset:1368
  v_mfma_f32_16x16x32_bf16 v[176:179], v[84:87], v[32:35], v[176:179]
  ds_read_b64 v[56:57], v3 offset:2528
  ds_read_b64 v[58:59], v3 offset:2536
  v_mfma_f32_16x16x32_bf16 v[192:195], v[92:95], v[32:35], v[192:195]
  ds_read_b64 v[60:61], v3 offset:3696
  ds_read_b64 v[62:63], v3 offset:3704
  v_mfma_f32_16x16x32_bf16 v[208:211], v[100:103], v[32:35], v[208:211]
  v_add_f32 v24, v135, v138
  v_add_f32 v25, v139, v142
  v_mfma_f32_16x16x32_bf16 v[224:227], v[108:111], v[32:35], v[224:227]
  v_add_f32 v24, v24, v141
  ds_bpermute_b32 v31, v7, v25
  v_mfma_f32_16x16x32_bf16 v[240:243], v[116:119], v[32:35], v[240:243]
  ds_bpermute_b32 v11, v7, v143
  ds_bpermute_b32 v30, v7, v24
  s_waitcnt lgkmcnt(15)
  v_mfma_f32_16x16x32_bf16 v[148:151], v[68:71], v[36:39], v[148:151]
  v_add_f32 v21, v129, v132
  v_add_f32 v22, v130, v133
  v_mfma_f32_16x16x32_bf16 v[164:167], v[76:79], v[36:39], v[164:167]
  v_add_f32 v23, v131, v134
  v_add_f32 v22, v22, v136
  v_mfma_f32_16x16x32_bf16 v[180:183], v[84:87], v[36:39], v[180:183]
  v_add_f32 v23, v23, v137
  v_add_f32 v23, v23, v140
  v_mfma_f32_16x16x32_bf16 v[196:199], v[92:95], v[36:39], v[196:199]
  v_mfma_f32_16x16x32_bf16 v[212:215], v[100:103], v[36:39], v[212:215]
  v_mfma_f32_16x16x32_bf16 v[228:231], v[108:111], v[36:39], v[228:231]
  v_mfma_f32_16x16x32_bf16 v[244:247], v[116:119], v[36:39], v[244:247]
  s_waitcnt lgkmcnt(13)
  v_mfma_f32_16x16x32_bf16 v[152:155], v[68:71], v[40:43], v[152:155]
  v_mfma_f32_16x16x32_bf16 v[168:171], v[76:79], v[40:43], v[168:171]
  v_mfma_f32_16x16x32_bf16 v[184:187], v[84:87], v[40:43], v[184:187]
  v_mfma_f32_16x16x32_bf16 v[200:203], v[92:95], v[40:43], v[200:203]
  v_mfma_f32_16x16x32_bf16 v[216:219], v[100:103], v[40:43], v[216:219]
  v_mfma_f32_16x16x32_bf16 v[232:235], v[108:111], v[40:43], v[232:235]
  v_mfma_f32_16x16x32_bf16 v[248:251], v[116:119], v[40:43], v[248:251]
  s_waitcnt lgkmcnt(11)
  v_mfma_f32_16x16x32_bf16 v[156:159], v[68:71], v[44:47], v[156:159]
  v_mfma_f32_16x16x32_bf16 v[172:175], v[76:79], v[44:47], v[172:175]
  s_waitcnt lgkmcnt(0)
  v_cndmask_b32 v24, v30, v27, s[70:71]
  v_cndmask_b32 v25, v31, v28, s[70:71]
  v_mfma_f32_16x16x32_bf16 v[188:191], v[84:87], v[44:47], v[188:191]
  v_cndmask_b32 v26, v11, v29, s[70:71]
  v_add_f32 v20, v128, v24
  v_mfma_f32_16x16x32_bf16 v[204:207], v[92:95], v[44:47], v[204:207]
  v_add_f32 v21, v21, v25
  v_add_f32 v22, v22, v26
  v_mfma_f32_16x16x32_bf16 v[220:223], v[100:103], v[44:47], v[220:223]
  v_cvt_pk_bf16_f32 v24, v20, v21
  v_cvt_pk_bf16_f32 v25, v22, v23
  v_mfma_f32_16x16x32_bf16 v[236:239], v[108:111], v[44:47], v[236:239]
  ds_write_b16 v5, v24 offset:0
  ds_write_b16_d16_hi v5, v24 offset:144
  v_mfma_f32_16x16x32_bf16 v[252:255], v[116:119], v[44:47], v[252:255]
  ds_write_b16 v5, v25 offset:288
  ds_write_b16_d16_hi v5, v25 offset:432
  v_mov_b32 v4, 3
  ds_write_b32 v6, v4
  v_mfma_f32_16x16x32_bf16 v[144:147], v[64:67], v[48:51], v[144:147]
  ds_read_b64 v[32:33], v3 offset:256
  ds_read_b64 v[34:35], v3 offset:264
  v_mfma_f32_16x16x32_bf16 v[160:163], v[72:75], v[48:51], v[160:163]
  ds_read_b64 v[36:37], v3 offset:1424
  ds_read_b64 v[38:39], v3 offset:1432
  v_mfma_f32_16x16x32_bf16 v[176:179], v[80:83], v[48:51], v[176:179]
  ds_read_b64 v[40:41], v3 offset:2592
  ds_read_b64 v[42:43], v3 offset:2600
  v_mfma_f32_16x16x32_bf16 v[192:195], v[88:91], v[48:51], v[192:195]
  ds_read_b64 v[44:45], v3 offset:3760
  ds_read_b64 v[46:47], v3 offset:3768
  v_mfma_f32_16x16x32_bf16 v[208:211], v[96:99], v[48:51], v[208:211]
  v_mfma_f32_16x16x32_bf16 v[224:227], v[104:107], v[48:51], v[224:227]
  v_mfma_f32_16x16x32_bf16 v[240:243], v[112:115], v[48:51], v[240:243]
  v_mfma_f32_16x16x32_bf16 v[148:151], v[64:67], v[52:55], v[148:151]
  v_mfma_f32_16x16x32_bf16 v[164:167], v[72:75], v[52:55], v[164:167]
  v_mfma_f32_16x16x32_bf16 v[180:183], v[80:83], v[52:55], v[180:183]
  v_mfma_f32_16x16x32_bf16 v[196:199], v[88:91], v[52:55], v[196:199]
  v_mfma_f32_16x16x32_bf16 v[212:215], v[96:99], v[52:55], v[212:215]
  v_mfma_f32_16x16x32_bf16 v[228:231], v[104:107], v[52:55], v[228:231]
  v_mfma_f32_16x16x32_bf16 v[244:247], v[112:115], v[52:55], v[244:247]
  v_mfma_f32_16x16x32_bf16 v[152:155], v[64:67], v[56:59], v[152:155]
  v_mfma_f32_16x16x32_bf16 v[168:171], v[72:75], v[56:59], v[168:171]
  v_mfma_f32_16x16x32_bf16 v[184:187], v[80:83], v[56:59], v[184:187]
  v_mfma_f32_16x16x32_bf16 v[200:203], v[88:91], v[56:59], v[200:203]
  v_mfma_f32_16x16x32_bf16 v[216:219], v[96:99], v[56:59], v[216:219]
  v_mfma_f32_16x16x32_bf16 v[232:235], v[104:107], v[56:59], v[232:235]
  v_mfma_f32_16x16x32_bf16 v[248:251], v[112:115], v[56:59], v[248:251]
  v_mfma_f32_16x16x32_bf16 v[156:159], v[64:67], v[60:63], v[156:159]
  v_mfma_f32_16x16x32_bf16 v[172:175], v[72:75], v[60:63], v[172:175]
  v_mfma_f32_16x16x32_bf16 v[188:191], v[80:83], v[60:63], v[188:191]
  v_mfma_f32_16x16x32_bf16 v[204:207], v[88:91], v[60:63], v[204:207]
  v_mfma_f32_16x16x32_bf16 v[220:223], v[96:99], v[60:63], v[220:223]
  v_mfma_f32_16x16x32_bf16 v[236:239], v[104:107], v[60:63], v[236:239]
  v_mfma_f32_16x16x32_bf16 v[252:255], v[112:115], v[60:63], v[252:255]
  s_waitcnt lgkmcnt(6)
  v_mfma_f32_16x16x32_bf16 v[160:163], v[68:71], v[32:35], v[160:163]
  ds_read_b64 v[48:49], v3 offset:320
  ds_read_b64 v[50:51], v3 offset:328
  v_mfma_f32_16x16x32_bf16 v[176:179], v[76:79], v[32:35], v[176:179]
  ds_read_b64 v[52:53], v3 offset:1488
  ds_read_b64 v[54:55], v3 offset:1496
  v_mfma_f32_16x16x32_bf16 v[192:195], v[84:87], v[32:35], v[192:195]
  ds_read_b64 v[56:57], v3 offset:2656
  ds_read_b64 v[58:59], v3 offset:2664
  v_mfma_f32_16x16x32_bf16 v[208:211], v[92:95], v[32:35], v[208:211]
  ds_read_b64 v[60:61], v3 offset:3824
  ds_read_b64 v[62:63], v3 offset:3832
  v_mfma_f32_16x16x32_bf16 v[224:227], v[100:103], v[32:35], v[224:227]
  v_add_f32 v24, v151, v154
  v_add_f32 v25, v155, v158
  v_mfma_f32_16x16x32_bf16 v[240:243], v[108:111], v[32:35], v[240:243]
  v_add_f32 v24, v24, v157
  ds_bpermute_b32 v28, v7, v25
  s_waitcnt lgkmcnt(13)
  v_mfma_f32_16x16x32_bf16 v[164:167], v[68:71], v[36:39], v[164:167]
  ds_bpermute_b32 v29, v7, v159
  ds_bpermute_b32 v27, v7, v24
  v_mfma_f32_16x16x32_bf16 v[180:183], v[76:79], v[36:39], v[180:183]
  v_add_f32 v21, v145, v148
  v_add_f32 v22, v146, v149
  v_mfma_f32_16x16x32_bf16 v[196:199], v[84:87], v[36:39], v[196:199]
  v_add_f32 v23, v147, v150
  v_add_f32 v22, v22, v152
  v_mfma_f32_16x16x32_bf16 v[212:215], v[92:95], v[36:39], v[212:215]
  v_add_f32 v23, v23, v153
  v_add_f32 v23, v23, v156
  v_mfma_f32_16x16x32_bf16 v[228:231], v[100:103], v[36:39], v[228:231]
  v_mfma_f32_16x16x32_bf16 v[244:247], v[108:111], v[36:39], v[244:247]
  s_waitcnt lgkmcnt(13)
  v_mfma_f32_16x16x32_bf16 v[168:171], v[68:71], v[40:43], v[168:171]
  v_mfma_f32_16x16x32_bf16 v[184:187], v[76:79], v[40:43], v[184:187]
  v_mfma_f32_16x16x32_bf16 v[200:203], v[84:87], v[40:43], v[200:203]
  v_mfma_f32_16x16x32_bf16 v[216:219], v[92:95], v[40:43], v[216:219]
  v_mfma_f32_16x16x32_bf16 v[232:235], v[100:103], v[40:43], v[232:235]
  v_mfma_f32_16x16x32_bf16 v[248:251], v[108:111], v[40:43], v[248:251]
  s_waitcnt lgkmcnt(11)
  v_mfma_f32_16x16x32_bf16 v[172:175], v[68:71], v[44:47], v[172:175]
  s_waitcnt lgkmcnt(0)
  v_cndmask_b32 v24, v27, v30, s[70:71]
  v_cndmask_b32 v25, v28, v31, s[70:71]
  v_mfma_f32_16x16x32_bf16 v[188:191], v[76:79], v[44:47], v[188:191]
  v_cndmask_b32 v26, v29, v11, s[70:71]
  v_add_f32 v20, v144, v24
  v_mfma_f32_16x16x32_bf16 v[204:207], v[84:87], v[44:47], v[204:207]
  v_add_f32 v21, v21, v25
  v_add_f32 v22, v22, v26
  v_mfma_f32_16x16x32_bf16 v[220:223], v[92:95], v[44:47], v[220:223]
  v_cvt_pk_bf16_f32 v24, v20, v21
  v_cvt_pk_bf16_f32 v25, v22, v23
  v_mfma_f32_16x16x32_bf16 v[236:239], v[100:103], v[44:47], v[236:239]
  ds_write_b16 v5, v24 offset:2304
  ds_write_b16_d16_hi v5, v24 offset:2448
  v_mfma_f32_16x16x32_bf16 v[252:255], v[108:111], v[44:47], v[252:255]
  ds_write_b16 v5, v25 offset:2592
  ds_write_b16_d16_hi v5, v25 offset:2736
  v_mov_b32 v4, 4
  ds_write_b32 v6, v4
  v_mfma_f32_16x16x32_bf16 v[160:163], v[64:67], v[48:51], v[160:163]
  ds_read_b64 v[32:33], v3 offset:384
  ds_read_b64 v[34:35], v3 offset:392
  v_mfma_f32_16x16x32_bf16 v[176:179], v[72:75], v[48:51], v[176:179]
  ds_read_b64 v[36:37], v3 offset:1552
  ds_read_b64 v[38:39], v3 offset:1560
  v_mfma_f32_16x16x32_bf16 v[192:195], v[80:83], v[48:51], v[192:195]
  ds_read_b64 v[40:41], v3 offset:2720
  ds_read_b64 v[42:43], v3 offset:2728
  v_mfma_f32_16x16x32_bf16 v[208:211], v[88:91], v[48:51], v[208:211]
  ds_read_b64 v[44:45], v3 offset:3888
  ds_read_b64 v[46:47], v3 offset:3896
  v_mfma_f32_16x16x32_bf16 v[224:227], v[96:99], v[48:51], v[224:227]
  v_mfma_f32_16x16x32_bf16 v[240:243], v[104:107], v[48:51], v[240:243]
  v_mfma_f32_16x16x32_bf16 v[164:167], v[64:67], v[52:55], v[164:167]
  v_mfma_f32_16x16x32_bf16 v[180:183], v[72:75], v[52:55], v[180:183]
  v_mfma_f32_16x16x32_bf16 v[196:199], v[80:83], v[52:55], v[196:199]
  v_mfma_f32_16x16x32_bf16 v[212:215], v[88:91], v[52:55], v[212:215]
  v_mfma_f32_16x16x32_bf16 v[228:231], v[96:99], v[52:55], v[228:231]
  v_mfma_f32_16x16x32_bf16 v[244:247], v[104:107], v[52:55], v[244:247]
  v_mfma_f32_16x16x32_bf16 v[168:171], v[64:67], v[56:59], v[168:171]
  v_mfma_f32_16x16x32_bf16 v[184:187], v[72:75], v[56:59], v[184:187]
  v_mfma_f32_16x16x32_bf16 v[200:203], v[80:83], v[56:59], v[200:203]
  v_mfma_f32_16x16x32_bf16 v[216:219], v[88:91], v[56:59], v[216:219]
  v_mfma_f32_16x16x32_bf16 v[232:235], v[96:99], v[56:59], v[232:235]
  v_mfma_f32_16x16x32_bf16 v[248:251], v[104:107], v[56:59], v[248:251]
  v_mfma_f32_16x16x32_bf16 v[172:175], v[64:67], v[60:63], v[172:175]
  v_mfma_f32_16x16x32_bf16 v[188:191], v[72:75], v[60:63], v[188:191]
  v_mfma_f32_16x16x32_bf16 v[204:207], v[80:83], v[60:63], v[204:207]
  v_mfma_f32_16x16x32_bf16 v[220:223], v[88:91], v[60:63], v[220:223]
  v_mfma_f32_16x16x32_bf16 v[236:239], v[96:99], v[60:63], v[236:239]
  v_mfma_f32_16x16x32_bf16 v[252:255], v[104:107], v[60:63], v[252:255]
  s_waitcnt lgkmcnt(6)
  v_mfma_f32_16x16x32_bf16 v[176:179], v[68:71], v[32:35], v[176:179]
  ds_read_b64 v[48:49], v3 offset:448
  ds_read_b64 v[50:51], v3 offset:456
  v_mfma_f32_16x16x32_bf16 v[192:195], v[76:79], v[32:35], v[192:195]
  ds_read_b64 v[52:53], v3 offset:1616
  ds_read_b64 v[54:55], v3 offset:1624
  v_mfma_f32_16x16x32_bf16 v[208:211], v[84:87], v[32:35], v[208:211]
  ds_read_b64 v[56:57], v3 offset:2784
  ds_read_b64 v[58:59], v3 offset:2792
  v_mfma_f32_16x16x32_bf16 v[224:227], v[92:95], v[32:35], v[224:227]
  ds_read_b64 v[60:61], v3 offset:3952
  ds_read_b64 v[62:63], v3 offset:3960
  v_mfma_f32_16x16x32_bf16 v[240:243], v[100:103], v[32:35], v[240:243]
  v_add_f32 v24, v167, v170
  v_add_f32 v25, v171, v174
  s_waitcnt lgkmcnt(12)
  v_mfma_f32_16x16x32_bf16 v[180:183], v[68:71], v[36:39], v[180:183]
  v_add_f32 v24, v24, v173
  ds_bpermute_b32 v31, v7, v25
  v_mfma_f32_16x16x32_bf16 v[196:199], v[76:79], v[36:39], v[196:199]
  ds_bpermute_b32 v11, v7, v175
  ds_bpermute_b32 v30, v7, v24
  v_mfma_f32_16x16x32_bf16 v[212:215], v[84:87], v[36:39], v[212:215]
  v_add_f32 v21, v161, v164
  v_add_f32 v22, v162, v165
  v_mfma_f32_16x16x32_bf16 v[228:231], v[92:95], v[36:39], v[228:231]
  v_add_f32 v23, v163, v166
  v_add_f32 v22, v22, v168
  v_mfma_f32_16x16x32_bf16 v[244:247], v[100:103], v[36:39], v[244:247]
  v_add_f32 v23, v23, v169
  v_add_f32 v23, v23, v172
  s_waitcnt lgkmcnt(13)
  v_mfma_f32_16x16x32_bf16 v[184:187], v[68:71], v[40:43], v[184:187]
  v_mfma_f32_16x16x32_bf16 v[200:203], v[76:79], v[40:43], v[200:203]
  v_mfma_f32_16x16x32_bf16 v[216:219], v[84:87], v[40:43], v[216:219]
  v_mfma_f32_16x16x32_bf16 v[232:235], v[92:95], v[40:43], v[232:235]
  v_mfma_f32_16x16x32_bf16 v[248:251], v[100:103], v[40:43], v[248:251]
  s_waitcnt lgkmcnt(0)
  v_cndmask_b32 v24, v30, v27, s[70:71]
  v_cndmask_b32 v25, v31, v28, s[70:71]
  v_mfma_f32_16x16x32_bf16 v[188:191], v[68:71], v[44:47], v[188:191]
  v_cndmask_b32 v26, v11, v29, s[70:71]
  v_add_f32 v20, v160, v24
  v_mfma_f32_16x16x32_bf16 v[204:207], v[76:79], v[44:47], v[204:207]
  v_add_f32 v21, v21, v25
  v_add_f32 v22, v22, v26
  v_mfma_f32_16x16x32_bf16 v[220:223], v[84:87], v[44:47], v[220:223]
  v_cvt_pk_bf16_f32 v24, v20, v21
  v_cvt_pk_bf16_f32 v25, v22, v23
  v_mfma_f32_16x16x32_bf16 v[236:239], v[92:95], v[44:47], v[236:239]
  ds_write_b16 v5, v24 offset:4608
  ds_write_b16_d16_hi v5, v24 offset:4752
  v_mfma_f32_16x16x32_bf16 v[252:255], v[100:103], v[44:47], v[252:255]
  ds_write_b16 v5, v25 offset:4896
  ds_write_b16_d16_hi v5, v25 offset:5040
  v_mov_b32 v4, 5
  ds_write_b32 v6, v4
  v_mfma_f32_16x16x32_bf16 v[176:179], v[64:67], v[48:51], v[176:179]
  ds_read_b64 v[32:33], v3 offset:512
  ds_read_b64 v[34:35], v3 offset:520
  v_mfma_f32_16x16x32_bf16 v[192:195], v[72:75], v[48:51], v[192:195]
  ds_read_b64 v[36:37], v3 offset:1680
  ds_read_b64 v[38:39], v3 offset:1688
  v_mfma_f32_16x16x32_bf16 v[208:211], v[80:83], v[48:51], v[208:211]
  ds_read_b64 v[40:41], v3 offset:2848
  ds_read_b64 v[42:43], v3 offset:2856
  v_mfma_f32_16x16x32_bf16 v[224:227], v[88:91], v[48:51], v[224:227]
  ds_read_b64 v[44:45], v3 offset:4016
  ds_read_b64 v[46:47], v3 offset:4024
  v_mfma_f32_16x16x32_bf16 v[240:243], v[96:99], v[48:51], v[240:243]
  v_mfma_f32_16x16x32_bf16 v[180:183], v[64:67], v[52:55], v[180:183]
  v_mfma_f32_16x16x32_bf16 v[196:199], v[72:75], v[52:55], v[196:199]
  v_mfma_f32_16x16x32_bf16 v[212:215], v[80:83], v[52:55], v[212:215]
  v_mfma_f32_16x16x32_bf16 v[228:231], v[88:91], v[52:55], v[228:231]
  v_mfma_f32_16x16x32_bf16 v[244:247], v[96:99], v[52:55], v[244:247]
  v_mfma_f32_16x16x32_bf16 v[184:187], v[64:67], v[56:59], v[184:187]
  v_mfma_f32_16x16x32_bf16 v[200:203], v[72:75], v[56:59], v[200:203]
  v_mfma_f32_16x16x32_bf16 v[216:219], v[80:83], v[56:59], v[216:219]
  v_mfma_f32_16x16x32_bf16 v[232:235], v[88:91], v[56:59], v[232:235]
  v_mfma_f32_16x16x32_bf16 v[248:251], v[96:99], v[56:59], v[248:251]
  v_mfma_f32_16x16x32_bf16 v[188:191], v[64:67], v[60:63], v[188:191]
  v_mfma_f32_16x16x32_bf16 v[204:207], v[72:75], v[60:63], v[204:207]
  v_mfma_f32_16x16x32_bf16 v[220:223], v[80:83], v[60:63], v[220:223]
  v_mfma_f32_16x16x32_bf16 v[236:239], v[88:91], v[60:63], v[236:239]
  v_mfma_f32_16x16x32_bf16 v[252:255], v[96:99], v[60:63], v[252:255]
  s_waitcnt lgkmcnt(6)
  v_mfma_f32_16x16x32_bf16 v[192:195], v[68:71], v[32:35], v[192:195]
  ds_read_b64 v[48:49], v3 offset:576
  ds_read_b64 v[50:51], v3 offset:584
  v_mfma_f32_16x16x32_bf16 v[208:211], v[76:79], v[32:35], v[208:211]
  ds_read_b64 v[52:53], v3 offset:1744
  ds_read_b64 v[54:55], v3 offset:1752
  v_mfma_f32_16x16x32_bf16 v[224:227], v[84:87], v[32:35], v[224:227]
  ds_read_b64 v[56:57], v3 offset:2912
  ds_read_b64 v[58:59], v3 offset:2920
  v_mfma_f32_16x16x32_bf16 v[240:243], v[92:95], v[32:35], v[240:243]
  ds_read_b64 v[60:61], v3 offset:4080
  ds_read_b64 v[62:63], v3 offset:4088
  s_waitcnt lgkmcnt(12)
  v_mfma_f32_16x16x32_bf16 v[196:199], v[68:71], v[36:39], v[196:199]
  v_add_f32 v24, v183, v186
  v_add_f32 v25, v187, v190
  v_mfma_f32_16x16x32_bf16 v[212:215], v[76:79], v[36:39], v[212:215]
  v_add_f32 v24, v24, v189
  ds_bpermute_b32 v28, v7, v25
  v_mfma_f32_16x16x32_bf16 v[228:231], v[84:87], v[36:39], v[228:231]
  ds_bpermute_b32 v29, v7, v191
  ds_bpermute_b32 v27, v7, v24
  v_mfma_f32_16x16x32_bf16 v[244:247], v[92:95], v[36:39], v[244:247]
  v_add_f32 v21, v177, v180
  v_add_f32 v22, v178, v181
  s_waitcnt lgkmcnt(13)
  v_mfma_f32_16x16x32_bf16 v[200:203], v[68:71], v[40:43], v[200:203]
  v_add_f32 v23, v179, v182
  v_add_f32 v22, v22, v184
  v_mfma_f32_16x16x32_bf16 v[216:219], v[76:79], v[40:43], v[216:219]
  v_add_f32 v23, v23, v185
  v_add_f32 v23, v23, v188
  v_mfma_f32_16x16x32_bf16 v[232:235], v[84:87], v[40:43], v[232:235]
  v_mfma_f32_16x16x32_bf16 v[248:251], v[92:95], v[40:43], v[248:251]
  s_waitcnt lgkmcnt(11)
  v_mfma_f32_16x16x32_bf16 v[204:207], v[68:71], v[44:47], v[204:207]
  v_mfma_f32_16x16x32_bf16 v[220:223], v[76:79], v[44:47], v[220:223]
  s_waitcnt lgkmcnt(0)
  v_cndmask_b32 v24, v27, v30, s[70:71]
  v_cndmask_b32 v25, v28, v31, s[70:71]
  v_mfma_f32_16x16x32_bf16 v[236:239], v[84:87], v[44:47], v[236:239]
  v_cndmask_b32 v26, v29, v11, s[70:71]
  v_add_f32 v20, v176, v24
  v_mfma_f32_16x16x32_bf16 v[252:255], v[92:95], v[44:47], v[252:255]
  v_add_f32 v21, v21, v25
  v_add_f32 v22, v22, v26
  v_cvt_pk_bf16_f32 v24, v20, v21
  v_cvt_pk_bf16_f32 v25, v22, v23
  ds_write_b16 v5, v24 offset:6912
  ds_write_b16_d16_hi v5, v24 offset:7056
  ds_write_b16 v5, v25 offset:7200
  ds_write_b16_d16_hi v5, v25 offset:7344
  v_mov_b32 v4, 6
  ds_write_b32 v6, v4
  v_mfma_f32_16x16x32_bf16 v[192:195], v[64:67], v[48:51], v[192:195]
  ds_read_b64 v[32:33], v3 offset:640
  ds_read_b64 v[34:35], v3 offset:648
  v_mfma_f32_16x16x32_bf16 v[208:211], v[72:75], v[48:51], v[208:211]
  ds_read_b64 v[36:37], v3 offset:1808
  ds_read_b64 v[38:39], v3 offset:1816
  v_mfma_f32_16x16x32_bf16 v[224:227], v[80:83], v[48:51], v[224:227]
  ds_read_b64 v[40:41], v3 offset:2976
  ds_read_b64 v[42:43], v3 offset:2984
  v_mfma_f32_16x16x32_bf16 v[240:243], v[88:91], v[48:51], v[240:243]
  ds_read_b64 v[44:45], v3 offset:4144
  ds_read_b64 v[46:47], v3 offset:4152
  v_mfma_f32_16x16x32_bf16 v[196:199], v[64:67], v[52:55], v[196:199]
  ds_read_b64 v[96:97], v3 offset:704
  ds_read_b64 v[98:99], v3 offset:712
  v_mfma_f32_16x16x32_bf16 v[212:215], v[72:75], v[52:55], v[212:215]
  ds_read_b64 v[100:101], v3 offset:1872
  ds_read_b64 v[102:103], v3 offset:1880
  v_mfma_f32_16x16x32_bf16 v[228:231], v[80:83], v[52:55], v[228:231]
  ds_read_b64 v[104:105], v3 offset:3040
  ds_read_b64 v[106:107], v3 offset:3048
  v_mfma_f32_16x16x32_bf16 v[244:247], v[88:91], v[52:55], v[244:247]
  ds_read_b64 v[108:109], v3 offset:4208
  ds_read_b64 v[110:111], v3 offset:4216
  v_mfma_f32_16x16x32_bf16 v[200:203], v[64:67], v[56:59], v[200:203]
  ds_read_b64 v[128:129], v3 offset:768
  ds_read_b64 v[130:131], v3 offset:776
  v_mfma_f32_16x16x32_bf16 v[216:219], v[72:75], v[56:59], v[216:219]
  ds_read_b64 v[132:133], v3 offset:1936
  ds_read_b64 v[134:135], v3 offset:1944
  v_mfma_f32_16x16x32_bf16 v[232:235], v[80:83], v[56:59], v[232:235]
  ds_read_b64 v[136:137], v3 offset:3104
  ds_read_b64 v[138:139], v3 offset:3112
  v_mfma_f32_16x16x32_bf16 v[248:251], v[88:91], v[56:59], v[248:251]
  ds_read_b64 v[140:141], v3 offset:4272
  ds_read_b64 v[142:143], v3 offset:4280
  v_mfma_f32_16x16x32_bf16 v[204:207], v[64:67], v[60:63], v[204:207]
  ds_read_b64 v[144:145], v3 offset:832
  ds_read_b64 v[146:147], v3 offset:840
  v_mfma_f32_16x16x32_bf16 v[220:223], v[72:75], v[60:63], v[220:223]
  ds_read_b64 v[148:149], v3 offset:2000
  ds_read_b64 v[150:151], v3 offset:2008
  v_mfma_f32_16x16x32_bf16 v[236:239], v[80:83], v[60:63], v[236:239]
  ds_read_b64 v[152:153], v3 offset:3168
  ds_read_b64 v[154:155], v3 offset:3176
  v_mfma_f32_16x16x32_bf16 v[252:255], v[88:91], v[60:63], v[252:255]
  ds_read_b64 v[156:157], v3 offset:4336
  ds_read_b64 v[158:159], v3 offset:4344
  ds_read_b64 v[160:161], v3 offset:896
  ds_read_b64 v[162:163], v3 offset:904
  ds_read_b64 v[164:165], v3 offset:2064
  ds_read_b64 v[166:167], v3 offset:2072
  ds_read_b64 v[168:169], v3 offset:3232
  ds_read_b64 v[170:171], v3 offset:3240
  ds_read_b64 v[172:173], v3 offset:4400
  ds_read_b64 v[174:175], v3 offset:4408
  ds_read_b64 v[176:177], v3 offset:960
  ds_read_b64 v[178:179], v3 offset:968
  ds_read_b64 v[180:181], v3 offset:2128
  ds_read_b64 v[182:183], v3 offset:2136
  ds_read_b64 v[184:185], v3 offset:3296
  ds_read_b64 v[186:187], v3 offset:3304
  ds_read_b64 v[188:189], v3 offset:4464
  ds_read_b64 v[190:191], v3 offset:4472
  s_waitcnt lgkmcnt(15)
  v_mfma_f32_16x16x32_bf16 v[208:211], v[68:71], v[32:35], v[208:211]
  v_add_f32 v24, v199, v202
  v_add_f32 v25, v203, v206
  v_mfma_f32_16x16x32_bf16 v[212:215], v[68:71], v[36:39], v[212:215]
  v_add_f32 v24, v24, v205
  ds_bpermute_b32 v31, v7, v25
  v_mfma_f32_16x16x32_bf16 v[216:219], v[68:71], v[40:43], v[216:219]
  ds_bpermute_b32 v11, v7, v207
  ds_bpermute_b32 v30, v7, v24
  v_mfma_f32_16x16x32_bf16 v[220:223], v[68:71], v[44:47], v[220:223]
  v_add_f32 v21, v193, v196
  v_add_f32 v22, v194, v197
  v_mfma_f32_16x16x32_bf16 v[208:211], v[64:67], v[96:99], v[208:211]
  v_add_f32 v23, v195, v198
  v_add_f32 v22, v22, v200
  v_mfma_f32_16x16x32_bf16 v[212:215], v[64:67], v[100:103], v[212:215]
  v_add_f32 v23, v23, v201
  v_add_f32 v23, v23, v204
  v_mfma_f32_16x16x32_bf16 v[216:219], v[64:67], v[104:107], v[216:219]
  v_mfma_f32_16x16x32_bf16 v[220:223], v[64:67], v[108:111], v[220:223]
  s_waitcnt lgkmcnt(0)
  v_cndmask_b32 v24, v30, v27, s[70:71]
  v_cndmask_b32 v25, v31, v28, s[70:71]
  v_cndmask_b32 v26, v11, v29, s[70:71]
  v_add_f32 v20, v192, v24
  v_add_f32 v21, v21, v25
  v_add_f32 v22, v22, v26
  v_cvt_pk_bf16_f32 v24, v20, v21
  v_cvt_pk_bf16_f32 v25, v22, v23
  ds_write_b16 v5, v24 offset:9216
  ds_write_b16_d16_hi v5, v24 offset:9360
  ds_write_b16 v5, v25 offset:9504
  ds_write_b16_d16_hi v5, v25 offset:9648
  v_mov_b32 v4, 7
  ds_write_b32 v6, v4
  v_mfma_f32_16x16x32_bf16 v[224:227], v[76:79], v[32:35], v[224:227]
  v_add_f32 v24, v215, v218
  v_add_f32 v25, v219, v222
  v_mfma_f32_16x16x32_bf16 v[228:231], v[76:79], v[36:39], v[228:231]
  v_add_f32 v24, v24, v221
  ds_bpermute_b32 v28, v7, v25
  v_mfma_f32_16x16x32_bf16 v[232:235], v[76:79], v[40:43], v[232:235]
  ds_bpermute_b32 v29, v7, v223
  ds_bpermute_b32 v27, v7, v24
  v_mfma_f32_16x16x32_bf16 v[236:239], v[76:79], v[44:47], v[236:239]
  v_add_f32 v21, v209, v212
  v_add_f32 v22, v210, v213
  v_mfma_f32_16x16x32_bf16 v[224:227], v[72:75], v[96:99], v[224:227]
  v_add_f32 v23, v211, v214
  v_add_f32 v22, v22, v216
  v_mfma_f32_16x16x32_bf16 v[228:231], v[72:75], v[100:103], v[228:231]
  v_add_f32 v23, v23, v217
  v_add_f32 v23, v23, v220
  v_mfma_f32_16x16x32_bf16 v[232:235], v[72:75], v[104:107], v[232:235]
  v_mfma_f32_16x16x32_bf16 v[236:239], v[72:75], v[108:111], v[236:239]
  v_mfma_f32_16x16x32_bf16 v[224:227], v[68:71], v[128:131], v[224:227]
  v_mfma_f32_16x16x32_bf16 v[228:231], v[68:71], v[132:135], v[228:231]
  v_mfma_f32_16x16x32_bf16 v[232:235], v[68:71], v[136:139], v[232:235]
  s_waitcnt lgkmcnt(0)
  v_cndmask_b32 v24, v27, v30, s[70:71]
  v_cndmask_b32 v25, v28, v31, s[70:71]
  v_mfma_f32_16x16x32_bf16 v[236:239], v[68:71], v[140:143], v[236:239]
  v_cndmask_b32 v26, v29, v11, s[70:71]
  v_add_f32 v20, v208, v24
  v_mfma_f32_16x16x32_bf16 v[224:227], v[64:67], v[144:147], v[224:227]
  v_add_f32 v21, v21, v25
  v_add_f32 v22, v22, v26
  v_mfma_f32_16x16x32_bf16 v[228:231], v[64:67], v[148:151], v[228:231]
  v_cvt_pk_bf16_f32 v24, v20, v21
  v_cvt_pk_bf16_f32 v25, v22, v23
  v_mfma_f32_16x16x32_bf16 v[232:235], v[64:67], v[152:155], v[232:235]
  ds_write_b16 v5, v24 offset:11520
  ds_write_b16_d16_hi v5, v24 offset:11664
  v_mfma_f32_16x16x32_bf16 v[236:239], v[64:67], v[156:159], v[236:239]
  ds_write_b16 v5, v25 offset:11808
  ds_write_b16_d16_hi v5, v25 offset:11952
  v_mov_b32 v4, 8
  ds_write_b32 v6, v4
  v_mfma_f32_16x16x32_bf16 v[240:243], v[84:87], v[32:35], v[240:243]
  v_add_f32 v24, v231, v234
  s_nop 1
  v_add_f32 v25, v235, v238
  v_mfma_f32_16x16x32_bf16 v[244:247], v[84:87], v[36:39], v[244:247]
  v_add_f32 v24, v24, v237
  ds_bpermute_b32 v31, v7, v25
  v_mfma_f32_16x16x32_bf16 v[248:251], v[84:87], v[40:43], v[248:251]
  ds_bpermute_b32 v11, v7, v239
  ds_bpermute_b32 v30, v7, v24
  v_mfma_f32_16x16x32_bf16 v[252:255], v[84:87], v[44:47], v[252:255]
  v_add_f32 v21, v225, v228
  v_add_f32 v22, v226, v229
  v_mfma_f32_16x16x32_bf16 v[240:243], v[80:83], v[96:99], v[240:243]
  v_add_f32 v23, v227, v230
  v_add_f32 v22, v22, v232
  v_mfma_f32_16x16x32_bf16 v[244:247], v[80:83], v[100:103], v[244:247]
  v_add_f32 v23, v23, v233
  v_add_f32 v23, v23, v236
  v_mfma_f32_16x16x32_bf16 v[248:251], v[80:83], v[104:107], v[248:251]
  v_mfma_f32_16x16x32_bf16 v[252:255], v[80:83], v[108:111], v[252:255]
  v_mfma_f32_16x16x32_bf16 v[240:243], v[76:79], v[128:131], v[240:243]
  v_mfma_f32_16x16x32_bf16 v[244:247], v[76:79], v[132:135], v[244:247]
  v_mfma_f32_16x16x32_bf16 v[248:251], v[76:79], v[136:139], v[248:251]
  v_mfma_f32_16x16x32_bf16 v[252:255], v[76:79], v[140:143], v[252:255]
  v_mfma_f32_16x16x32_bf16 v[240:243], v[72:75], v[144:147], v[240:243]
  v_mfma_f32_16x16x32_bf16 v[244:247], v[72:75], v[148:151], v[244:247]
  v_mfma_f32_16x16x32_bf16 v[248:251], v[72:75], v[152:155], v[248:251]
  v_mfma_f32_16x16x32_bf16 v[252:255], v[72:75], v[156:159], v[252:255]
  v_mfma_f32_16x16x32_bf16 v[240:243], v[68:71], v[160:163], v[240:243]
  v_mfma_f32_16x16x32_bf16 v[244:247], v[68:71], v[164:167], v[244:247]
  v_mfma_f32_16x16x32_bf16 v[248:251], v[68:71], v[168:171], v[248:251]
  s_waitcnt lgkmcnt(0)
  v_cndmask_b32 v24, v30, v27, s[70:71]
  v_cndmask_b32 v25, v31, v28, s[70:71]
  v_mfma_f32_16x16x32_bf16 v[252:255], v[68:71], v[172:175], v[252:255]
  v_cndmask_b32 v26, v11, v29, s[70:71]
  v_add_f32 v20, v224, v24
  v_mfma_f32_16x16x32_bf16 v[240:243], v[64:67], v[176:179], v[240:243]
  v_add_f32 v21, v21, v25
  v_add_f32 v22, v22, v26
  v_mfma_f32_16x16x32_bf16 v[244:247], v[64:67], v[180:183], v[244:247]
  v_cvt_pk_bf16_f32 v24, v20, v21
  v_cvt_pk_bf16_f32 v25, v22, v23
  v_mfma_f32_16x16x32_bf16 v[248:251], v[64:67], v[184:187], v[248:251]
  ds_write_b16 v5, v24 offset:13824
  ds_write_b16_d16_hi v5, v24 offset:13968
  v_mfma_f32_16x16x32_bf16 v[252:255], v[64:67], v[188:191], v[252:255]
  ds_write_b16 v5, v25 offset:14112
  ds_write_b16_d16_hi v5, v25 offset:14256
  v_mov_b32 v4, 9
  ds_write_b32 v6, v4
  s_nop 0
  v_add_f32 v24, v247, v250
  s_nop 1
  v_add_f32 v25, v251, v254
  v_add_f32 v24, v24, v253
  ds_bpermute_b32 v28, v7, v25
  ds_bpermute_b32 v29, v7, v255
  ds_bpermute_b32 v27, v7, v24
  v_add_f32 v21, v241, v244
  v_add_f32 v22, v242, v245
  v_add_f32 v23, v243, v246
  v_add_f32 v22, v22, v248
  v_add_f32 v23, v23, v249
  v_add_f32 v23, v23, v252
  s_waitcnt lgkmcnt(0)
  v_cndmask_b32 v24, v27, v30, s[70:71]
  v_cndmask_b32 v25, v28, v31, s[70:71]
  v_cndmask_b32 v26, v29, v11, s[70:71]
  v_add_f32 v20, v240, v24
  v_add_f32 v21, v21, v25
  v_add_f32 v22, v22, v26
  v_cvt_pk_bf16_f32 v24, v20, v21
  v_cvt_pk_bf16_f32 v25, v22, v23
  ds_write_b16 v5, v24 offset:16128
  ds_write_b16_d16_hi v5, v24 offset:16272
  ds_write_b16 v5, v25 offset:16416
  ds_write_b16_d16_hi v5, v25 offset:16560
  v_mov_b32 v4, 10
  ds_write_b32 v6, v4
  s_waitcnt lgkmcnt(0)
  s_cmp_eq_u32 s6, 4
  s_cbranch_scc0 L_nobump
  s_waitcnt vmcnt(0)
  v_readfirstlane_b32 s7, v8
  s_nop 0
  s_cmp_eq_u32 s7, 0xff
  s_cbranch_scc0 L_nobump
  s_add_u32 s7, s75, 1
  s_mov_b64 exec, 1
  v_mov_b32 v9, 65536
  v_mov_b32 v1, s7
  global_store_dword v9, v1, s[48:49] sc1
  s_mov_b64 exec, -1
L_nobump:
L_done:
L_end:
  s_endpgm
L_codeend:
.section .rodata,"a"
.p2align 6
.amdhsa_kernel gated_mix__ssm_conv_s4d__ssm_conv_h3__prompt_kernel
  .amdhsa_next_free_vgpr 256
  .amdhsa_next_free_sgpr 100
  .amdhsa_accum_offset 256
  .amdhsa_group_segment_fixed_size 0
  .amdhsa_kernarg_size 136
  .amdhsa_user_sgpr_count 2
  .amdhsa_user_sgpr_kernarg_segment_ptr 1
  .amdhsa_system_sgpr_workgroup_id_x 1
  .amdhsa_float_denorm_mode_32 3
.end_amdhsa_kernel
```
